```python
import torch

def _softmax(x, axis=-1):
    return torch.softmax(x, dim=axis)
def _gelu(x):
    return torch.nn.functional.gelu(x, approximate="tanh")
def _silu(x):
    return torch.nn.functional.silu(x)
def _sigmoid(x):
    return torch.sigmoid(x)
def _layernorm(x, axis=-1, eps=1e-5):
    m = x.mean(dim=axis, keepdim=True)
    v = x.var(dim=axis, keepdim=True, unbiased=False)
    return (x - m) / torch.sqrt(v + eps)
def _scatter_add(tgt, idx, src, axis=0):
    return tgt.clone().index_add_(axis, idx, src)
def _segment_sum(src, seg, n):
    out = torch.zeros((n,) + src.shape[1:], dtype=src.dtype)
    return out.index_add_(0, seg, src)
def _pad(x, pw):
    flat = tuple(v for pair in reversed(pw) for v in pair)
    return torch.nn.functional.pad(x, flat)

kernel_name = 'concat_heads__linear_kernel_hedgehog__spectral_fnet__prompt'

def setup_inputs():

    _w = (lambda a: (lambda t: t.to(torch.bfloat16) if t.is_floating_point() else t)(torch.as_tensor(a)))
    def _A_setup():
        B, S, D, H = 1, 2048, 512, 32
        Dh = D // H
        return {
            "x": _w((lambda *s: torch.randn(*s, dtype=torch.bfloat16) * 0.2)(B, S, D)),
            "wqkv": _w((lambda *s: torch.randn(*s, dtype=torch.bfloat16) * 1.6)(D, 3 * D)),
            "w_phi": _w((lambda *s: torch.randn(*s, dtype=torch.bfloat16) * 1.6)(H, Dh, Dh) * (Dh ** -0.5)),
            "wo": _w((lambda *s: torch.randn(*s, dtype=torch.bfloat16) * 0.8)(D, D)),
        }
    _A_in = _A_setup()

    def _B_setup():
        B, S, D = 1, 2048, 512
        ns = torch.arange(S)[:, None] * torch.arange(S)[None, :]
        nd = torch.arange(D)[:, None] * torch.arange(D)[None, :]
        Ws_re = torch.cos(-2.0 * torch.pi * ns / S).to(float)
        Ws_im = torch.sin(-2.0 * torch.pi * ns / S).to(float)
        Wd_re = torch.cos(-2.0 * torch.pi * nd / D).to(float)
        Wd_im = torch.sin(-2.0 * torch.pi * nd / D).to(float)
        return {
            "x": _w((lambda *s: torch.randn(*s, dtype=torch.bfloat16) * 0.05)(B, S, D)),
            "dft_seq_re": _w(Ws_re),
            "dft_seq_im": _w(Ws_im),
            "dft_hid_re": _w(Wd_re),
            "dft_hid_im": _w(Wd_im),
        }
    _B_in = _B_setup()

    return {
        "A_x": _A_in["x"],
        "A_wqkv": _A_in["wqkv"],
        "A_w_phi": _A_in["w_phi"],
        "A_wo": _A_in["wo"],
        "B_x": _B_in["x"],
        "B_dft_seq_re": _B_in["dft_seq_re"],
        "B_dft_seq_im": _B_in["dft_seq_im"],
        "B_dft_hid_re": _B_in["dft_hid_re"],
        "B_dft_hid_im": _B_in["dft_hid_im"],
    }

def reference(A_x, A_wqkv, A_w_phi, A_wo, B_x, B_dft_seq_re, B_dft_seq_im, B_dft_hid_re, B_dft_hid_im):
    def _A_ref(x, wqkv, w_phi, wo):
        B, S, D = x.shape
        H = 32; Dh = D // H
        qkv = (lambda x, *d: x.permute(*d))((x @ wqkv).reshape(B, S, 3, H, Dh), 2, 0, 3, 1, 4)
        q, k, v = qkv[0], qkv[1], qkv[2]
        pq = torch.einsum("bhsd,hdf->bhsf", q, w_phi)
        pk = torch.einsum("bhsd,hdf->bhsf", k, w_phi)
        phi_q = torch.concatenate([_softmax(pq, axis=-1), _softmax(-pq, axis=-1)], axis=-1)
        phi_k = torch.concatenate([_softmax(pk, axis=-1), _softmax(-pk, axis=-1)], axis=-1)
        kv = torch.einsum("bhsf,bhsd->bhfd", phi_k, v)
        z  = torch.einsum("bhsf->bhf", phi_k)
        num = torch.einsum("bhqf,bhfd->bhqd", phi_q, kv)
        den = torch.einsum("bhqf,bhf->bhq", phi_q, z)[..., None] + 1e-6
        o = num / den
        return (lambda x, *d: x.permute(*d))(o, 0, 2, 1, 3).reshape(B, S, D) @ wo

    def _B_ref(x, dft_seq_re, dft_seq_im, dft_hid_re, dft_hid_im):
        a = torch.einsum("bsd,ed->bse", x, dft_hid_re)
        b = torch.einsum("bsd,ed->bse", x, dft_hid_im)
        y = torch.einsum("ts,bse->bte", dft_seq_re, a) - torch.einsum("ts,bse->bte", dft_seq_im, b)
        return y

    a = _A_ref(A_x, A_wqkv, A_w_phi, A_wo)
    b = _B_ref(B_x, B_dft_seq_re, B_dft_seq_im, B_dft_hid_re, B_dft_hid_im)
    return torch.concatenate([a, b], axis=-1)
```

```asm
; @launch kernel=k1_kernel grid=(256,1,1) block=(512,1,1) lds=163840
.amdgcn_target "amdgcn-amd-amdhsa--gfx950"
.text
.globl k1_kernel
.p2align 8
.type k1_kernel,@function
k1_kernel:
s_cmp_ge_u32 s2, 256
s_cbranch_scc1 K1_END
s_load_dwordx16 s[32:47], s[0:1], 0
s_load_dwordx8 s[48:55], s[0:1], 64
s_getpc_b64 s[84:85]
K1_PC:
v_lshrrev_b32 v1, 6, v0
v_and_b32 v0, 63, v0
v_readfirstlane_b32 s3, v1
s_and_b32 s4, s2, 7
s_lshr_b32 s5, s2, 3
s_lshr_b32 s6, s5, 3
s_and_b32 s7, s5, 7
s_lshr_b32 s8, s4, 1
s_lshl_b32 s8, s8, 2
s_add_u32 s8, s8, s6
s_and_b32 s9, s4, 1
s_lshl_b32 s9, s9, 3
s_add_u32 s9, s9, s7
s_lshl_b32 s10, s4, 2
s_add_u32 s10, s10, s6
s_cmp_lg_u32 s3, 4
s_cbranch_scc1 K1_NCPF
s_lshl_b32 s18, s5, 10
v_lshlrev_b32 v1, 7, v0
v_add_u32 v1, s18, v1
v_min_u32 v1, K_TEXT_END-K1_PC-4, v1
s_mov_b64 exec, 0xff
global_load_dword v6, v1, s[84:85]
s_mov_b64 exec, -1
K1_NCPF:
s_add_u32 s86, s4, s7
s_lshl_b32 s87, s6, 1
s_add_u32 s87, s87, s86
s_mov_b32 s26, s3
s_mov_b32 s28, 0x3fb8aa3b
s_mov_b32 s29, 0xbfb8aa3b
s_cmp_lt_u32 s3, 4
s_cbranch_scc1 K1_COMPUTE
s_sub_u32 s3, s3, 4
s_setprio 3
s_and_b32 s18, s3, 1
s_lshl_b32 s18, s18, 2
v_lshrrev_b32 v10, 4, v0
v_add_u32 v11, s18, v10
v_and_b32 v12, 7, v0
v_xor_b32 v11, v11, v12
v_lshlrev_b32 v11, 4, v11
v_lshrrev_b32 v12, 3, v0
v_lshl_or_b32 v1, v12, 10, v11
v_lshrrev_b32 v11, 2, v0
v_mul_u32_u24 v11, 0xc00, v11
v_and_b32 v12, 3, v0
v_lshl_or_b32 v2, v12, 4, v11
s_lshl_b32 s12, s8, 17
s_lshl_b32 s18, s3, 13
s_add_u32 s12, s12, s18
s_mul_i32 s13, s3, 0xc000
s_lshl_b32 s18, s9, 6
s_add_u32 s13, s13, s18
s_lshl_b32 s14, s3, 10
s_mov_b32 s58, 0x200000
s_mov_b32 s59, 0x00020000
s_mov_b32 s62, 0x180000
s_mov_b32 s63, 0x00020000
s_waitcnt lgkmcnt(0)
s_mov_b32 s56, s32
s_mov_b32 s57, s33
s_mov_b32 s60, s34
s_mov_b32 s61, s35
s_mov_b32 s88, s36
s_mov_b32 s89, s37
s_mov_b32 s90, 0x4000
s_mov_b32 s91, 0x00020000
v_lshlrev_b32 v12, 4, v0
s_lshl_b32 s18, s3, 8
s_add_u32 m0, s18, 0x17000
s_lshl_b32 s19, s9, 10
s_add_u32 s18, s18, s19
s_mov_b64 exec, 0xffff
buffer_load_dwordx4 v12, s[88:91], s18 offen lds
s_mov_b64 exec, -1
s_mov_b32 s64, s40
s_mov_b32 s65, s41
s_mov_b32 s66, 0x200000
s_mov_b32 s67, 0x00020000
s_mov_b32 s76, s54
s_mov_b32 s77, s55
s_mov_b32 s78, 0x4000000
s_mov_b32 s79, 0x00020000
s_lshl_b32 s18, s3, 2
v_add_u32 v11, s18, v10
v_and_b32 v12, 15, v0
v_xor_b32 v11, v11, v12
v_lshlrev_b32 v11, 4, v11
v_lshl_or_b32 v3, v10, 15, v11
s_lshl_b32 s15, s3, 7
s_add_u32 s15, s15, s10
s_lshl_b32 s15, s15, 10
v_and_b32 v252, 3, v0
v_lshlrev_b32 v252, 2, v252
v_add_u32 v252, 0x17400, v252
s_lshl_b32 s18, s3, 2
s_add_u32 s18, s18, 0x17400
v_mov_b32 v253, s18
v_mov_b32 v254, 1
s_cmp_lg_u32 s3, 0
s_cbranch_scc1 K1_NOFZ
v_lshlrev_b32 v11, 3, v0
v_add_u32 v11, 0x17400, v11
v_mov_b32 v240, 0
v_mov_b32 v241, 0
ds_write_b64 v11, v[240:241]
K1_NOFZ:
v_mov_b32 v96, 0
s_or_b32 s80, s8, s3
s_lshl_b32 s18, s9, 3
s_add_u32 s82, s52, s18
s_addc_u32 s83, s53, 0
s_cmp_lg_u32 s80, 0
s_cbranch_scc1 K1_HNOCLAIM
v_mov_b32 v97, 1
s_mov_b64 exec, 1
global_atomic_add v98, v96, v97, s[82:83] sc0
s_mov_b64 exec, -1
K1_HNOCLAIM:
s_lshl_b32 s81, s2, 3
s_add_u32 s81, s81, s3
s_cmp_lg_u32 s81, 1
s_cbranch_scc1 K1_HNOEP
v_and_b32 v100, 7, v0
v_lshlrev_b32 v100, 8, v100
v_lshrrev_b32 v101, 3, v0
v_lshl_or_b32 v100, v101, 11, v100
s_mov_b32 s18, 0x1000000
buffer_store_dword v96, v100, s[76:79], s18 offen sc1
v_lshlrev_b32 v100, 8, v0
s_mov_b32 s18, 0x1020000
buffer_store_dword v96, v100, s[76:79], s18 offen sc1
v_lshlrev_b32 v101, 7, v0
s_mov_b32 s18, 0x1010000
buffer_store_dword v96, v101, s[76:79], s18 offen sc1
s_add_u32 s18, s18, 0x2000
buffer_store_dword v96, v101, s[76:79], s18 offen sc1
K1_HNOEP:
v_and_b32 v36, 31, v0
s_lshr_b32 s27, s3, 1
s_lshl_b32 s27, s27, 5
v_add_u32 v15, s27, v36
v_and_b32 v11, 3, v36
v_and_b32 v12, 4, v36
v_lshl_or_b32 v11, v12, 1, v11
v_and_b32 v12, 8, v36
v_lshrrev_b32 v12, 1, v12
v_or_b32 v11, v11, v12
v_and_b32 v12, 16, v36
v_or_b32 v4, v11, v12
v_lshrrev_b32 v10, 5, v0
s_lshl_b32 s27, s3, 5
v_add_u32 v11, s27, v36
v_lshrrev_b32 v12, 1, v11
v_and_b32 v12, 7, v12
v_xor_b32 v12, v12, v10
v_lshlrev_b32 v12, 4, v12
v_lshl_or_b32 v32, v11, 7, v12
v_xor_b32 v33, 0x20, v32
v_xor_b32 v34, 0x40, v32
v_xor_b32 v35, 0x60, v32
v_lshrrev_b32 v11, 2, v0
v_and_b32 v11, 3, v11
v_lshl_or_b32 v11, v10, 3, v11
v_lshlrev_b32 v11, 6, v11
v_and_b32 v12, 16, v0
v_lshl_or_b32 v11, v12, 1, v11
v_and_b32 v12, 1, v0
v_lshl_or_b32 v37, v12, 4, v11
v_and_b32 v12, 2, v0
v_lshl_or_b32 v37, v12, 2, v37
v_lshrrev_b32 v11, 5, v0
v_lshrrev_b32 v12, 2, v0
v_and_b32 v12, 3, v12
v_lshl_or_b32 v11, v11, 3, v12
v_lshlrev_b32 v11, 5, v11
v_and_b32 v12, 16, v0
v_lshl_or_b32 v11, v12, 5, v11
v_and_b32 v12, 1, v0
v_lshl_or_b32 v11, v12, 4, v11
v_and_b32 v12, 2, v0
v_lshl_or_b32 v11, v12, 2, v11
v_add_u32 v5, 0x17000, v11
s_lshl_b32 s27, s7, 5
v_add_u32 v240, s27, v4
s_and_b32 s30, s3, 1
s_lshl_b32 s20, s30, 7
v_mov_b32 v241, s20
s_xor_b32 s30, s30, 1
s_or_b32 s30, s30, s7
v_cmp_eq_u32 vcc, 0, v4
s_cmp_eq_u32 s30, 0
s_nop 2
s_cselect_b64 s[20:21], vcc, 0
v_mov_b32 v242, 0x100
v_cndmask_b32 v240, v240, v242, s[20:21]
v_cndmask_b32 v241, v241, 0, s[20:21]
s_and_b32 s27, s86, 3
s_lshl_b32 s27, s27, 7
v_lshrrev_b32 v242, 5, v0
v_lshlrev_b32 v242, 3, v242
v_add_u32 v242, s27, v242
v_mul_u32_u24 v242, v242, v240
v_add_u32 v242, v242, v241
v_cvt_f32_u32 v242, v242
v_cvt_f32_u32 v240, v240
s_mov_b32 s27, 0x3b000000
v_mul_f32 v242, s27, v242
v_mul_f32 v240, s27, v240
v_fract_f32 v242, v242
v_mul_f32 v241, 0x41800000, v240
v_cos_f32 v80, v241
v_sub_f32 v243, v242, v241
v_add_f32 v80, v80, v80
v_cos_f32 v56, v242
v_cos_f32 v64, v243
v_add_f32 v242, v242, v240
v_add_f32 v243, v243, v240
v_cos_f32 v57, v242
v_cos_f32 v65, v243
v_add_f32 v242, v242, v240
v_add_f32 v243, v243, v240
v_cos_f32 v58, v242
v_cos_f32 v66, v243
v_add_f32 v242, v242, v240
v_add_f32 v243, v243, v240
v_cos_f32 v59, v242
v_cos_f32 v67, v243
v_add_f32 v242, v242, v240
v_add_f32 v243, v243, v240
v_cos_f32 v60, v242
v_cos_f32 v68, v243
v_add_f32 v242, v242, v240
v_add_f32 v243, v243, v240
v_cos_f32 v61, v242
v_cos_f32 v69, v243
v_add_f32 v242, v242, v240
v_add_f32 v243, v243, v240
v_cos_f32 v62, v242
v_cos_f32 v70, v243
v_add_f32 v242, v242, v240
v_add_f32 v243, v243, v240
v_cos_f32 v63, v242
v_cos_f32 v71, v243
v_cvt_pk_bf16_f32 v112, v56, v57
v_cvt_pk_bf16_f32 v113, v58, v59
v_cvt_pk_bf16_f32 v114, v60, v61
v_cvt_pk_bf16_f32 v115, v62, v63
v_pk_fma_f32 v[64:65], v[80:81], v[56:57], v[64:65] op_sel_hi:[0,1,1] neg_lo:[0,0,1] neg_hi:[0,0,1]
v_pk_fma_f32 v[66:67], v[80:81], v[58:59], v[66:67] op_sel_hi:[0,1,1] neg_lo:[0,0,1] neg_hi:[0,0,1]
v_pk_fma_f32 v[68:69], v[80:81], v[60:61], v[68:69] op_sel_hi:[0,1,1] neg_lo:[0,0,1] neg_hi:[0,0,1]
v_pk_fma_f32 v[70:71], v[80:81], v[62:63], v[70:71] op_sel_hi:[0,1,1] neg_lo:[0,0,1] neg_hi:[0,0,1]
v_cvt_pk_bf16_f32 v116, v64, v65
v_cvt_pk_bf16_f32 v117, v66, v67
v_cvt_pk_bf16_f32 v118, v68, v69
v_cvt_pk_bf16_f32 v119, v70, v71
v_pk_fma_f32 v[56:57], v[80:81], v[64:65], v[56:57] op_sel_hi:[0,1,1] neg_lo:[0,0,1] neg_hi:[0,0,1]
v_pk_fma_f32 v[58:59], v[80:81], v[66:67], v[58:59] op_sel_hi:[0,1,1] neg_lo:[0,0,1] neg_hi:[0,0,1]
v_pk_fma_f32 v[60:61], v[80:81], v[68:69], v[60:61] op_sel_hi:[0,1,1] neg_lo:[0,0,1] neg_hi:[0,0,1]
v_pk_fma_f32 v[62:63], v[80:81], v[70:71], v[62:63] op_sel_hi:[0,1,1] neg_lo:[0,0,1] neg_hi:[0,0,1]
v_cvt_pk_bf16_f32 v120, v56, v57
v_cvt_pk_bf16_f32 v121, v58, v59
v_cvt_pk_bf16_f32 v122, v60, v61
v_cvt_pk_bf16_f32 v123, v62, v63
v_pk_fma_f32 v[64:65], v[80:81], v[56:57], v[64:65] op_sel_hi:[0,1,1] neg_lo:[0,0,1] neg_hi:[0,0,1]
v_pk_fma_f32 v[66:67], v[80:81], v[58:59], v[66:67] op_sel_hi:[0,1,1] neg_lo:[0,0,1] neg_hi:[0,0,1]
v_pk_fma_f32 v[68:69], v[80:81], v[60:61], v[68:69] op_sel_hi:[0,1,1] neg_lo:[0,0,1] neg_hi:[0,0,1]
v_pk_fma_f32 v[70:71], v[80:81], v[62:63], v[70:71] op_sel_hi:[0,1,1] neg_lo:[0,0,1] neg_hi:[0,0,1]
v_cvt_pk_bf16_f32 v124, v64, v65
v_cvt_pk_bf16_f32 v125, v66, v67
v_cvt_pk_bf16_f32 v126, v68, v69
v_cvt_pk_bf16_f32 v127, v70, v71
v_pk_fma_f32 v[56:57], v[80:81], v[64:65], v[56:57] op_sel_hi:[0,1,1] neg_lo:[0,0,1] neg_hi:[0,0,1]
v_pk_fma_f32 v[58:59], v[80:81], v[66:67], v[58:59] op_sel_hi:[0,1,1] neg_lo:[0,0,1] neg_hi:[0,0,1]
v_pk_fma_f32 v[60:61], v[80:81], v[68:69], v[60:61] op_sel_hi:[0,1,1] neg_lo:[0,0,1] neg_hi:[0,0,1]
v_pk_fma_f32 v[62:63], v[80:81], v[70:71], v[62:63] op_sel_hi:[0,1,1] neg_lo:[0,0,1] neg_hi:[0,0,1]
v_cvt_pk_bf16_f32 v128, v56, v57
v_cvt_pk_bf16_f32 v129, v58, v59
v_cvt_pk_bf16_f32 v130, v60, v61
v_cvt_pk_bf16_f32 v131, v62, v63
v_pk_fma_f32 v[64:65], v[80:81], v[56:57], v[64:65] op_sel_hi:[0,1,1] neg_lo:[0,0,1] neg_hi:[0,0,1]
v_pk_fma_f32 v[66:67], v[80:81], v[58:59], v[66:67] op_sel_hi:[0,1,1] neg_lo:[0,0,1] neg_hi:[0,0,1]
v_pk_fma_f32 v[68:69], v[80:81], v[60:61], v[68:69] op_sel_hi:[0,1,1] neg_lo:[0,0,1] neg_hi:[0,0,1]
v_pk_fma_f32 v[70:71], v[80:81], v[62:63], v[70:71] op_sel_hi:[0,1,1] neg_lo:[0,0,1] neg_hi:[0,0,1]
v_cvt_pk_bf16_f32 v132, v64, v65
v_cvt_pk_bf16_f32 v133, v66, v67
v_cvt_pk_bf16_f32 v134, v68, v69
v_cvt_pk_bf16_f32 v135, v70, v71
v_pk_fma_f32 v[56:57], v[80:81], v[64:65], v[56:57] op_sel_hi:[0,1,1] neg_lo:[0,0,1] neg_hi:[0,0,1]
v_pk_fma_f32 v[58:59], v[80:81], v[66:67], v[58:59] op_sel_hi:[0,1,1] neg_lo:[0,0,1] neg_hi:[0,0,1]
s_cmp_lg_u32 s80, 0
s_cbranch_scc1 K1_HNOZERO
s_waitcnt vmcnt(0)
v_readfirstlane_b32 s80, v98
s_nop 3
s_cmp_lg_u32 s80, 0
s_cbranch_scc1 K1_HNOZERO
v_mov_b32 v100, 0
v_mov_b32 v101, 0
v_mov_b32 v102, 0
v_mov_b32 v103, 0
v_lshlrev_b32 v104, 4, v0
s_lshl_b32 s18, s9, 12
buffer_store_dwordx4 v[100:103], v104, s[76:79], s18 offen offset:0 sc1
buffer_store_dwordx4 v[100:103], v104, s[76:79], s18 offen offset:1024 sc1
buffer_store_dwordx4 v[100:103], v104, s[76:79], s18 offen offset:2048 sc1
buffer_store_dwordx4 v[100:103], v104, s[76:79], s18 offen offset:3072 sc1
s_lshl_b32 s18, s9, 8
s_add_u32 s18, s18, 0x10000
s_mov_b64 exec, 0xffff
buffer_store_dwordx4 v[100:103], v104, s[76:79], s18 offen sc1
s_mov_b64 exec, -1
K1_HNOZERO:
v_pk_fma_f32 v[60:61], v[80:81], v[68:69], v[60:61] op_sel_hi:[0,1,1] neg_lo:[0,0,1] neg_hi:[0,0,1]
v_pk_fma_f32 v[62:63], v[80:81], v[70:71], v[62:63] op_sel_hi:[0,1,1] neg_lo:[0,0,1] neg_hi:[0,0,1]
v_cvt_pk_bf16_f32 v136, v56, v57
v_cvt_pk_bf16_f32 v137, v58, v59
v_cvt_pk_bf16_f32 v138, v60, v61
v_cvt_pk_bf16_f32 v139, v62, v63
v_pk_fma_f32 v[64:65], v[80:81], v[56:57], v[64:65] op_sel_hi:[0,1,1] neg_lo:[0,0,1] neg_hi:[0,0,1]
v_pk_fma_f32 v[66:67], v[80:81], v[58:59], v[66:67] op_sel_hi:[0,1,1] neg_lo:[0,0,1] neg_hi:[0,0,1]
v_pk_fma_f32 v[68:69], v[80:81], v[60:61], v[68:69] op_sel_hi:[0,1,1] neg_lo:[0,0,1] neg_hi:[0,0,1]
v_pk_fma_f32 v[70:71], v[80:81], v[62:63], v[70:71] op_sel_hi:[0,1,1] neg_lo:[0,0,1] neg_hi:[0,0,1]
v_cvt_pk_bf16_f32 v140, v64, v65
v_cvt_pk_bf16_f32 v141, v66, v67
v_cvt_pk_bf16_f32 v142, v68, v69
v_cvt_pk_bf16_f32 v143, v70, v71
v_pk_fma_f32 v[56:57], v[80:81], v[64:65], v[56:57] op_sel_hi:[0,1,1] neg_lo:[0,0,1] neg_hi:[0,0,1]
v_pk_fma_f32 v[58:59], v[80:81], v[66:67], v[58:59] op_sel_hi:[0,1,1] neg_lo:[0,0,1] neg_hi:[0,0,1]
v_pk_fma_f32 v[60:61], v[80:81], v[68:69], v[60:61] op_sel_hi:[0,1,1] neg_lo:[0,0,1] neg_hi:[0,0,1]
v_pk_fma_f32 v[62:63], v[80:81], v[70:71], v[62:63] op_sel_hi:[0,1,1] neg_lo:[0,0,1] neg_hi:[0,0,1]
v_cvt_pk_bf16_f32 v144, v56, v57
v_cvt_pk_bf16_f32 v145, v58, v59
v_cvt_pk_bf16_f32 v146, v60, v61
v_cvt_pk_bf16_f32 v147, v62, v63
v_pk_fma_f32 v[64:65], v[80:81], v[56:57], v[64:65] op_sel_hi:[0,1,1] neg_lo:[0,0,1] neg_hi:[0,0,1]
v_pk_fma_f32 v[66:67], v[80:81], v[58:59], v[66:67] op_sel_hi:[0,1,1] neg_lo:[0,0,1] neg_hi:[0,0,1]
v_pk_fma_f32 v[68:69], v[80:81], v[60:61], v[68:69] op_sel_hi:[0,1,1] neg_lo:[0,0,1] neg_hi:[0,0,1]
v_pk_fma_f32 v[70:71], v[80:81], v[62:63], v[70:71] op_sel_hi:[0,1,1] neg_lo:[0,0,1] neg_hi:[0,0,1]
v_cvt_pk_bf16_f32 v148, v64, v65
v_cvt_pk_bf16_f32 v149, v66, v67
v_cvt_pk_bf16_f32 v150, v68, v69
v_cvt_pk_bf16_f32 v151, v70, v71
v_pk_fma_f32 v[56:57], v[80:81], v[64:65], v[56:57] op_sel_hi:[0,1,1] neg_lo:[0,0,1] neg_hi:[0,0,1]
v_pk_fma_f32 v[58:59], v[80:81], v[66:67], v[58:59] op_sel_hi:[0,1,1] neg_lo:[0,0,1] neg_hi:[0,0,1]
v_pk_fma_f32 v[60:61], v[80:81], v[68:69], v[60:61] op_sel_hi:[0,1,1] neg_lo:[0,0,1] neg_hi:[0,0,1]
v_pk_fma_f32 v[62:63], v[80:81], v[70:71], v[62:63] op_sel_hi:[0,1,1] neg_lo:[0,0,1] neg_hi:[0,0,1]
v_cvt_pk_bf16_f32 v152, v56, v57
v_cvt_pk_bf16_f32 v153, v58, v59
v_cvt_pk_bf16_f32 v154, v60, v61
v_cvt_pk_bf16_f32 v155, v62, v63
v_pk_fma_f32 v[64:65], v[80:81], v[56:57], v[64:65] op_sel_hi:[0,1,1] neg_lo:[0,0,1] neg_hi:[0,0,1]
v_pk_fma_f32 v[66:67], v[80:81], v[58:59], v[66:67] op_sel_hi:[0,1,1] neg_lo:[0,0,1] neg_hi:[0,0,1]
v_pk_fma_f32 v[68:69], v[80:81], v[60:61], v[68:69] op_sel_hi:[0,1,1] neg_lo:[0,0,1] neg_hi:[0,0,1]
v_pk_fma_f32 v[70:71], v[80:81], v[62:63], v[70:71] op_sel_hi:[0,1,1] neg_lo:[0,0,1] neg_hi:[0,0,1]
v_cvt_pk_bf16_f32 v156, v64, v65
v_cvt_pk_bf16_f32 v157, v66, v67
v_cvt_pk_bf16_f32 v158, v68, v69
v_cvt_pk_bf16_f32 v159, v70, v71
v_pk_fma_f32 v[56:57], v[80:81], v[64:65], v[56:57] op_sel_hi:[0,1,1] neg_lo:[0,0,1] neg_hi:[0,0,1]
v_pk_fma_f32 v[58:59], v[80:81], v[66:67], v[58:59] op_sel_hi:[0,1,1] neg_lo:[0,0,1] neg_hi:[0,0,1]
v_pk_fma_f32 v[60:61], v[80:81], v[68:69], v[60:61] op_sel_hi:[0,1,1] neg_lo:[0,0,1] neg_hi:[0,0,1]
v_pk_fma_f32 v[62:63], v[80:81], v[70:71], v[62:63] op_sel_hi:[0,1,1] neg_lo:[0,0,1] neg_hi:[0,0,1]
v_cvt_pk_bf16_f32 v160, v56, v57
v_cvt_pk_bf16_f32 v161, v58, v59
v_cvt_pk_bf16_f32 v162, v60, v61
v_cvt_pk_bf16_f32 v163, v62, v63
v_pk_fma_f32 v[64:65], v[80:81], v[56:57], v[64:65] op_sel_hi:[0,1,1] neg_lo:[0,0,1] neg_hi:[0,0,1]
v_pk_fma_f32 v[66:67], v[80:81], v[58:59], v[66:67] op_sel_hi:[0,1,1] neg_lo:[0,0,1] neg_hi:[0,0,1]
v_pk_fma_f32 v[68:69], v[80:81], v[60:61], v[68:69] op_sel_hi:[0,1,1] neg_lo:[0,0,1] neg_hi:[0,0,1]
v_pk_fma_f32 v[70:71], v[80:81], v[62:63], v[70:71] op_sel_hi:[0,1,1] neg_lo:[0,0,1] neg_hi:[0,0,1]
v_cvt_pk_bf16_f32 v164, v64, v65
v_cvt_pk_bf16_f32 v165, v66, v67
v_cvt_pk_bf16_f32 v166, v68, v69
v_cvt_pk_bf16_f32 v167, v70, v71
v_pk_fma_f32 v[56:57], v[80:81], v[64:65], v[56:57] op_sel_hi:[0,1,1] neg_lo:[0,0,1] neg_hi:[0,0,1]
v_pk_fma_f32 v[58:59], v[80:81], v[66:67], v[58:59] op_sel_hi:[0,1,1] neg_lo:[0,0,1] neg_hi:[0,0,1]
v_pk_fma_f32 v[60:61], v[80:81], v[68:69], v[60:61] op_sel_hi:[0,1,1] neg_lo:[0,0,1] neg_hi:[0,0,1]
v_pk_fma_f32 v[62:63], v[80:81], v[70:71], v[62:63] op_sel_hi:[0,1,1] neg_lo:[0,0,1] neg_hi:[0,0,1]
v_cvt_pk_bf16_f32 v168, v56, v57
v_cvt_pk_bf16_f32 v169, v58, v59
v_cvt_pk_bf16_f32 v170, v60, v61
v_cvt_pk_bf16_f32 v171, v62, v63
v_pk_fma_f32 v[64:65], v[80:81], v[56:57], v[64:65] op_sel_hi:[0,1,1] neg_lo:[0,0,1] neg_hi:[0,0,1]
v_pk_fma_f32 v[66:67], v[80:81], v[58:59], v[66:67] op_sel_hi:[0,1,1] neg_lo:[0,0,1] neg_hi:[0,0,1]
v_pk_fma_f32 v[68:69], v[80:81], v[60:61], v[68:69] op_sel_hi:[0,1,1] neg_lo:[0,0,1] neg_hi:[0,0,1]
v_pk_fma_f32 v[70:71], v[80:81], v[62:63], v[70:71] op_sel_hi:[0,1,1] neg_lo:[0,0,1] neg_hi:[0,0,1]
v_cvt_pk_bf16_f32 v172, v64, v65
v_cvt_pk_bf16_f32 v173, v66, v67
v_cvt_pk_bf16_f32 v174, v68, v69
v_cvt_pk_bf16_f32 v175, v70, v71
v_pk_fma_f32 v[56:57], v[80:81], v[64:65], v[56:57] op_sel_hi:[0,1,1] neg_lo:[0,0,1] neg_hi:[0,0,1]
v_pk_fma_f32 v[58:59], v[80:81], v[66:67], v[58:59] op_sel_hi:[0,1,1] neg_lo:[0,0,1] neg_hi:[0,0,1]
v_pk_fma_f32 v[60:61], v[80:81], v[68:69], v[60:61] op_sel_hi:[0,1,1] neg_lo:[0,0,1] neg_hi:[0,0,1]
v_pk_fma_f32 v[62:63], v[80:81], v[70:71], v[62:63] op_sel_hi:[0,1,1] neg_lo:[0,0,1] neg_hi:[0,0,1]
v_cvt_pk_bf16_f32 v176, v56, v57
v_cvt_pk_bf16_f32 v177, v58, v59
v_cvt_pk_bf16_f32 v178, v60, v61
v_cvt_pk_bf16_f32 v179, v62, v63
v_pk_fma_f32 v[64:65], v[80:81], v[56:57], v[64:65] op_sel_hi:[0,1,1] neg_lo:[0,0,1] neg_hi:[0,0,1]
v_pk_fma_f32 v[66:67], v[80:81], v[58:59], v[66:67] op_sel_hi:[0,1,1] neg_lo:[0,0,1] neg_hi:[0,0,1]
v_pk_fma_f32 v[68:69], v[80:81], v[60:61], v[68:69] op_sel_hi:[0,1,1] neg_lo:[0,0,1] neg_hi:[0,0,1]
v_pk_fma_f32 v[70:71], v[80:81], v[62:63], v[70:71] op_sel_hi:[0,1,1] neg_lo:[0,0,1] neg_hi:[0,0,1]
v_cvt_pk_bf16_f32 v180, v64, v65
v_cvt_pk_bf16_f32 v181, v66, v67
v_cvt_pk_bf16_f32 v182, v68, v69
v_cvt_pk_bf16_f32 v183, v70, v71
v_pk_fma_f32 v[56:57], v[80:81], v[64:65], v[56:57] op_sel_hi:[0,1,1] neg_lo:[0,0,1] neg_hi:[0,0,1]
v_pk_fma_f32 v[58:59], v[80:81], v[66:67], v[58:59] op_sel_hi:[0,1,1] neg_lo:[0,0,1] neg_hi:[0,0,1]
v_pk_fma_f32 v[60:61], v[80:81], v[68:69], v[60:61] op_sel_hi:[0,1,1] neg_lo:[0,0,1] neg_hi:[0,0,1]
v_pk_fma_f32 v[62:63], v[80:81], v[70:71], v[62:63] op_sel_hi:[0,1,1] neg_lo:[0,0,1] neg_hi:[0,0,1]
v_cvt_pk_bf16_f32 v184, v56, v57
v_cvt_pk_bf16_f32 v185, v58, v59
v_cvt_pk_bf16_f32 v186, v60, v61
v_cvt_pk_bf16_f32 v187, v62, v63
v_pk_fma_f32 v[64:65], v[80:81], v[56:57], v[64:65] op_sel_hi:[0,1,1] neg_lo:[0,0,1] neg_hi:[0,0,1]
v_pk_fma_f32 v[66:67], v[80:81], v[58:59], v[66:67] op_sel_hi:[0,1,1] neg_lo:[0,0,1] neg_hi:[0,0,1]
v_pk_fma_f32 v[68:69], v[80:81], v[60:61], v[68:69] op_sel_hi:[0,1,1] neg_lo:[0,0,1] neg_hi:[0,0,1]
v_pk_fma_f32 v[70:71], v[80:81], v[62:63], v[70:71] op_sel_hi:[0,1,1] neg_lo:[0,0,1] neg_hi:[0,0,1]
v_cvt_pk_bf16_f32 v188, v64, v65
v_cvt_pk_bf16_f32 v189, v66, v67
v_cvt_pk_bf16_f32 v190, v68, v69
v_cvt_pk_bf16_f32 v191, v70, v71
v_pk_fma_f32 v[56:57], v[80:81], v[64:65], v[56:57] op_sel_hi:[0,1,1] neg_lo:[0,0,1] neg_hi:[0,0,1]
v_pk_fma_f32 v[58:59], v[80:81], v[66:67], v[58:59] op_sel_hi:[0,1,1] neg_lo:[0,0,1] neg_hi:[0,0,1]
v_pk_fma_f32 v[60:61], v[80:81], v[68:69], v[60:61] op_sel_hi:[0,1,1] neg_lo:[0,0,1] neg_hi:[0,0,1]
v_pk_fma_f32 v[62:63], v[80:81], v[70:71], v[62:63] op_sel_hi:[0,1,1] neg_lo:[0,0,1] neg_hi:[0,0,1]
v_cvt_pk_bf16_f32 v192, v56, v57
v_cvt_pk_bf16_f32 v193, v58, v59
v_cvt_pk_bf16_f32 v194, v60, v61
v_cvt_pk_bf16_f32 v195, v62, v63
v_pk_fma_f32 v[64:65], v[80:81], v[56:57], v[64:65] op_sel_hi:[0,1,1] neg_lo:[0,0,1] neg_hi:[0,0,1]
v_pk_fma_f32 v[66:67], v[80:81], v[58:59], v[66:67] op_sel_hi:[0,1,1] neg_lo:[0,0,1] neg_hi:[0,0,1]
v_pk_fma_f32 v[68:69], v[80:81], v[60:61], v[68:69] op_sel_hi:[0,1,1] neg_lo:[0,0,1] neg_hi:[0,0,1]
v_pk_fma_f32 v[70:71], v[80:81], v[62:63], v[70:71] op_sel_hi:[0,1,1] neg_lo:[0,0,1] neg_hi:[0,0,1]
v_cvt_pk_bf16_f32 v196, v64, v65
v_cvt_pk_bf16_f32 v197, v66, v67
v_cvt_pk_bf16_f32 v198, v68, v69
v_cvt_pk_bf16_f32 v199, v70, v71
v_pk_fma_f32 v[56:57], v[80:81], v[64:65], v[56:57] op_sel_hi:[0,1,1] neg_lo:[0,0,1] neg_hi:[0,0,1]
v_pk_fma_f32 v[58:59], v[80:81], v[66:67], v[58:59] op_sel_hi:[0,1,1] neg_lo:[0,0,1] neg_hi:[0,0,1]
v_pk_fma_f32 v[60:61], v[80:81], v[68:69], v[60:61] op_sel_hi:[0,1,1] neg_lo:[0,0,1] neg_hi:[0,0,1]
v_pk_fma_f32 v[62:63], v[80:81], v[70:71], v[62:63] op_sel_hi:[0,1,1] neg_lo:[0,0,1] neg_hi:[0,0,1]
v_cvt_pk_bf16_f32 v200, v56, v57
v_cvt_pk_bf16_f32 v201, v58, v59
v_cvt_pk_bf16_f32 v202, v60, v61
v_cvt_pk_bf16_f32 v203, v62, v63
v_pk_fma_f32 v[64:65], v[80:81], v[56:57], v[64:65] op_sel_hi:[0,1,1] neg_lo:[0,0,1] neg_hi:[0,0,1]
v_pk_fma_f32 v[66:67], v[80:81], v[58:59], v[66:67] op_sel_hi:[0,1,1] neg_lo:[0,0,1] neg_hi:[0,0,1]
v_pk_fma_f32 v[68:69], v[80:81], v[60:61], v[68:69] op_sel_hi:[0,1,1] neg_lo:[0,0,1] neg_hi:[0,0,1]
v_pk_fma_f32 v[70:71], v[80:81], v[62:63], v[70:71] op_sel_hi:[0,1,1] neg_lo:[0,0,1] neg_hi:[0,0,1]
v_cvt_pk_bf16_f32 v204, v64, v65
v_cvt_pk_bf16_f32 v205, v66, v67
v_cvt_pk_bf16_f32 v206, v68, v69
v_cvt_pk_bf16_f32 v207, v70, v71
v_pk_fma_f32 v[56:57], v[80:81], v[64:65], v[56:57] op_sel_hi:[0,1,1] neg_lo:[0,0,1] neg_hi:[0,0,1]
v_pk_fma_f32 v[58:59], v[80:81], v[66:67], v[58:59] op_sel_hi:[0,1,1] neg_lo:[0,0,1] neg_hi:[0,0,1]
v_pk_fma_f32 v[60:61], v[80:81], v[68:69], v[60:61] op_sel_hi:[0,1,1] neg_lo:[0,0,1] neg_hi:[0,0,1]
v_pk_fma_f32 v[62:63], v[80:81], v[70:71], v[62:63] op_sel_hi:[0,1,1] neg_lo:[0,0,1] neg_hi:[0,0,1]
v_cvt_pk_bf16_f32 v208, v56, v57
v_cvt_pk_bf16_f32 v209, v58, v59
v_cvt_pk_bf16_f32 v210, v60, v61
v_cvt_pk_bf16_f32 v211, v62, v63
v_pk_fma_f32 v[64:65], v[80:81], v[56:57], v[64:65] op_sel_hi:[0,1,1] neg_lo:[0,0,1] neg_hi:[0,0,1]
v_pk_fma_f32 v[66:67], v[80:81], v[58:59], v[66:67] op_sel_hi:[0,1,1] neg_lo:[0,0,1] neg_hi:[0,0,1]
v_pk_fma_f32 v[68:69], v[80:81], v[60:61], v[68:69] op_sel_hi:[0,1,1] neg_lo:[0,0,1] neg_hi:[0,0,1]
v_pk_fma_f32 v[70:71], v[80:81], v[62:63], v[70:71] op_sel_hi:[0,1,1] neg_lo:[0,0,1] neg_hi:[0,0,1]
v_cvt_pk_bf16_f32 v212, v64, v65
v_cvt_pk_bf16_f32 v213, v66, v67
v_cvt_pk_bf16_f32 v214, v68, v69
v_cvt_pk_bf16_f32 v215, v70, v71
v_pk_fma_f32 v[56:57], v[80:81], v[64:65], v[56:57] op_sel_hi:[0,1,1] neg_lo:[0,0,1] neg_hi:[0,0,1]
v_pk_fma_f32 v[58:59], v[80:81], v[66:67], v[58:59] op_sel_hi:[0,1,1] neg_lo:[0,0,1] neg_hi:[0,0,1]
v_pk_fma_f32 v[60:61], v[80:81], v[68:69], v[60:61] op_sel_hi:[0,1,1] neg_lo:[0,0,1] neg_hi:[0,0,1]
v_pk_fma_f32 v[62:63], v[80:81], v[70:71], v[62:63] op_sel_hi:[0,1,1] neg_lo:[0,0,1] neg_hi:[0,0,1]
v_cvt_pk_bf16_f32 v216, v56, v57
v_cvt_pk_bf16_f32 v217, v58, v59
v_cvt_pk_bf16_f32 v218, v60, v61
v_cvt_pk_bf16_f32 v219, v62, v63
v_pk_fma_f32 v[64:65], v[80:81], v[56:57], v[64:65] op_sel_hi:[0,1,1] neg_lo:[0,0,1] neg_hi:[0,0,1]
v_pk_fma_f32 v[66:67], v[80:81], v[58:59], v[66:67] op_sel_hi:[0,1,1] neg_lo:[0,0,1] neg_hi:[0,0,1]
v_pk_fma_f32 v[68:69], v[80:81], v[60:61], v[68:69] op_sel_hi:[0,1,1] neg_lo:[0,0,1] neg_hi:[0,0,1]
v_pk_fma_f32 v[70:71], v[80:81], v[62:63], v[70:71] op_sel_hi:[0,1,1] neg_lo:[0,0,1] neg_hi:[0,0,1]
v_cvt_pk_bf16_f32 v220, v64, v65
v_cvt_pk_bf16_f32 v221, v66, v67
v_cvt_pk_bf16_f32 v222, v68, v69
v_cvt_pk_bf16_f32 v223, v70, v71
v_pk_fma_f32 v[56:57], v[80:81], v[64:65], v[56:57] op_sel_hi:[0,1,1] neg_lo:[0,0,1] neg_hi:[0,0,1]
v_pk_fma_f32 v[58:59], v[80:81], v[66:67], v[58:59] op_sel_hi:[0,1,1] neg_lo:[0,0,1] neg_hi:[0,0,1]
v_pk_fma_f32 v[60:61], v[80:81], v[68:69], v[60:61] op_sel_hi:[0,1,1] neg_lo:[0,0,1] neg_hi:[0,0,1]
v_pk_fma_f32 v[62:63], v[80:81], v[70:71], v[62:63] op_sel_hi:[0,1,1] neg_lo:[0,0,1] neg_hi:[0,0,1]
v_cvt_pk_bf16_f32 v224, v56, v57
v_cvt_pk_bf16_f32 v225, v58, v59
v_cvt_pk_bf16_f32 v226, v60, v61
v_cvt_pk_bf16_f32 v227, v62, v63
v_pk_fma_f32 v[64:65], v[80:81], v[56:57], v[64:65] op_sel_hi:[0,1,1] neg_lo:[0,0,1] neg_hi:[0,0,1]
v_pk_fma_f32 v[66:67], v[80:81], v[58:59], v[66:67] op_sel_hi:[0,1,1] neg_lo:[0,0,1] neg_hi:[0,0,1]
v_pk_fma_f32 v[68:69], v[80:81], v[60:61], v[68:69] op_sel_hi:[0,1,1] neg_lo:[0,0,1] neg_hi:[0,0,1]
v_pk_fma_f32 v[70:71], v[80:81], v[62:63], v[70:71] op_sel_hi:[0,1,1] neg_lo:[0,0,1] neg_hi:[0,0,1]
v_cvt_pk_bf16_f32 v228, v64, v65
v_cvt_pk_bf16_f32 v229, v66, v67
v_cvt_pk_bf16_f32 v230, v68, v69
v_cvt_pk_bf16_f32 v231, v70, v71
v_pk_fma_f32 v[56:57], v[80:81], v[64:65], v[56:57] op_sel_hi:[0,1,1] neg_lo:[0,0,1] neg_hi:[0,0,1]
v_pk_fma_f32 v[58:59], v[80:81], v[66:67], v[58:59] op_sel_hi:[0,1,1] neg_lo:[0,0,1] neg_hi:[0,0,1]
v_pk_fma_f32 v[60:61], v[80:81], v[68:69], v[60:61] op_sel_hi:[0,1,1] neg_lo:[0,0,1] neg_hi:[0,0,1]
v_pk_fma_f32 v[62:63], v[80:81], v[70:71], v[62:63] op_sel_hi:[0,1,1] neg_lo:[0,0,1] neg_hi:[0,0,1]
v_cvt_pk_bf16_f32 v232, v56, v57
v_cvt_pk_bf16_f32 v233, v58, v59
v_cvt_pk_bf16_f32 v234, v60, v61
v_cvt_pk_bf16_f32 v235, v62, v63
v_pk_fma_f32 v[64:65], v[80:81], v[56:57], v[64:65] op_sel_hi:[0,1,1] neg_lo:[0,0,1] neg_hi:[0,0,1]
v_pk_fma_f32 v[66:67], v[80:81], v[58:59], v[66:67] op_sel_hi:[0,1,1] neg_lo:[0,0,1] neg_hi:[0,0,1]
v_pk_fma_f32 v[68:69], v[80:81], v[60:61], v[68:69] op_sel_hi:[0,1,1] neg_lo:[0,0,1] neg_hi:[0,0,1]
v_pk_fma_f32 v[70:71], v[80:81], v[62:63], v[70:71] op_sel_hi:[0,1,1] neg_lo:[0,0,1] neg_hi:[0,0,1]
v_cvt_pk_bf16_f32 v236, v64, v65
v_cvt_pk_bf16_f32 v237, v66, v67
v_cvt_pk_bf16_f32 v238, v68, v69
v_cvt_pk_bf16_f32 v239, v70, v71
v_pk_fma_f32 v[56:57], v[80:81], v[64:65], v[56:57] op_sel_hi:[0,1,1] neg_lo:[0,0,1] neg_hi:[0,0,1]
v_pk_fma_f32 v[58:59], v[80:81], v[66:67], v[58:59] op_sel_hi:[0,1,1] neg_lo:[0,0,1] neg_hi:[0,0,1]
v_pk_fma_f32 v[60:61], v[80:81], v[68:69], v[60:61] op_sel_hi:[0,1,1] neg_lo:[0,0,1] neg_hi:[0,0,1]
v_pk_fma_f32 v[62:63], v[80:81], v[70:71], v[62:63] op_sel_hi:[0,1,1] neg_lo:[0,0,1] neg_hi:[0,0,1]
v_cmp_lt_u32 vcc, 32, v15
v_subrev_u32 v240, 32, v15
s_nop 0
v_cndmask_b32 v240, v15, v240, vcc
v_mov_b32 v241, 0x3e800000
v_cndmask_b32 v241, 0, v241, vcc
v_cvt_f32_u32 v240, v240
v_mul_f32 v240, 0x3c800000, v240
v_lshrrev_b32 v243, 5, v0
v_lshlrev_b32 v243, 3, v243
s_and_b32 s27, s3, 2
s_add_u32 s27, s27, 0
s_and_b32 s27, s27, 3
s_lshl_b32 s27, s27, 4
v_add_u32 v242, s27, v243
v_cvt_f32_u32 v242, v242
v_fma_f32 v242, v242, v240, v241
v_cos_f32 v244, v242
v_add_f32 v242, v242, v240
v_cos_f32 v245, v242
v_add_f32 v242, v242, v240
v_cos_f32 v246, v242
v_add_f32 v242, v242, v240
v_cos_f32 v247, v242
v_add_f32 v242, v242, v240
v_cos_f32 v248, v242
v_add_f32 v242, v242, v240
v_cos_f32 v249, v242
v_add_f32 v242, v242, v240
v_cos_f32 v250, v242
v_add_f32 v242, v242, v240
v_cos_f32 v251, v242
v_cvt_pk_bf16_f32 v40, v244, v245
v_cvt_pk_bf16_f32 v41, v246, v247
v_cvt_pk_bf16_f32 v42, v248, v249
v_cvt_pk_bf16_f32 v43, v250, v251
s_and_b32 s27, s3, 2
s_add_u32 s27, s27, 1
s_and_b32 s27, s27, 3
s_lshl_b32 s27, s27, 4
v_add_u32 v242, s27, v243
v_cvt_f32_u32 v242, v242
v_fma_f32 v242, v242, v240, v241
v_cos_f32 v244, v242
v_add_f32 v242, v242, v240
v_cos_f32 v245, v242
v_add_f32 v242, v242, v240
v_cos_f32 v246, v242
v_add_f32 v242, v242, v240
v_cos_f32 v247, v242
v_add_f32 v242, v242, v240
v_cos_f32 v248, v242
v_add_f32 v242, v242, v240
v_cos_f32 v249, v242
v_add_f32 v242, v242, v240
v_cos_f32 v250, v242
v_add_f32 v242, v242, v240
v_cos_f32 v251, v242
v_cvt_pk_bf16_f32 v44, v244, v245
v_cvt_pk_bf16_f32 v45, v246, v247
v_cvt_pk_bf16_f32 v46, v248, v249
v_cvt_pk_bf16_f32 v47, v250, v251
s_and_b32 s27, s3, 2
s_add_u32 s27, s27, 2
s_and_b32 s27, s27, 3
s_lshl_b32 s27, s27, 4
v_add_u32 v242, s27, v243
v_cvt_f32_u32 v242, v242
v_fma_f32 v242, v242, v240, v241
v_cos_f32 v244, v242
v_add_f32 v242, v242, v240
v_cos_f32 v245, v242
v_add_f32 v242, v242, v240
v_cos_f32 v246, v242
v_add_f32 v242, v242, v240
v_cos_f32 v247, v242
v_add_f32 v242, v242, v240
v_cos_f32 v248, v242
v_add_f32 v242, v242, v240
v_cos_f32 v249, v242
v_add_f32 v242, v242, v240
v_cos_f32 v250, v242
v_add_f32 v242, v242, v240
v_cos_f32 v251, v242
v_cvt_pk_bf16_f32 v48, v244, v245
v_cvt_pk_bf16_f32 v49, v246, v247
v_cvt_pk_bf16_f32 v50, v248, v249
v_cvt_pk_bf16_f32 v51, v250, v251
s_and_b32 s27, s3, 2
s_add_u32 s27, s27, 3
s_and_b32 s27, s27, 3
s_lshl_b32 s27, s27, 4
v_add_u32 v242, s27, v243
v_cvt_f32_u32 v242, v242
v_fma_f32 v242, v242, v240, v241
v_cos_f32 v244, v242
v_add_f32 v242, v242, v240
v_cos_f32 v245, v242
v_add_f32 v242, v242, v240
v_cos_f32 v246, v242
v_add_f32 v242, v242, v240
v_cos_f32 v247, v242
v_add_f32 v242, v242, v240
v_cos_f32 v248, v242
v_add_f32 v242, v242, v240
v_cos_f32 v249, v242
v_add_f32 v242, v242, v240
v_cos_f32 v250, v242
v_add_f32 v242, v242, v240
v_cos_f32 v251, v242
v_cvt_pk_bf16_f32 v52, v244, v245
v_cvt_pk_bf16_f32 v53, v246, v247
v_cvt_pk_bf16_f32 v54, v248, v249
v_cvt_pk_bf16_f32 v55, v250, v251
s_cmp_eq_u32 s80, 0
s_cbranch_scc1 K1_HW0
s_cmp_lg_u32 s81, 1
s_cbranch_scc1 K1_HW1
K1_HW0:
s_waitcnt vmcnt(0)
K1_HW1:
s_waitcnt vmcnt(0) lgkmcnt(0)
s_barrier
s_cmp_lg_u32 s80, 0
s_cbranch_scc1 K1_HNOFLAG
v_mov_b32 v14, 0
v_mov_b32 v13, 1
s_mov_b64 exec, 1
global_atomic_add v14, v13, s[82:83] offset:4
s_mov_b64 exec, -1
K1_HNOFLAG:
s_cmp_lg_u32 s81, 1
s_cbranch_scc1 K1_HNOEP2
v_mov_b32 v14, 0
s_waitcnt vmcnt(0)
v_mov_b32 v13, 1
s_mov_b64 exec, 1
global_store_dword v14, v13, s[52:53] offset:128 sc1
s_mov_b64 exec, -1
K1_HNOEP2:
s_add_u32 s22, s87, 4
s_and_b32 s22, s22, 7
s_lshl_b32 s23, s22, 7
s_add_u32 s23, s23, s12
s_mul_i32 s24, s22, 0x30000
s_add_u32 s24, s24, s13
s_add_u32 m0, s14, 0x20000
s_add_u32 s18, s23, 0x0
buffer_load_dwordx4 v1, s[56:59], s18 offen lds
ds_read_b128 v[16:19], v32 offset:0
ds_read_b64_tr_b16 v[20:21], v37 offset:16384
ds_read_b64_tr_b16 v[22:23], v37 offset:16640
ds_read_b128 v[24:27], v33 offset:0
ds_read_b64_tr_b16 v[28:29], v37 offset:17408
ds_read_b64_tr_b16 v[30:31], v37 offset:17664
s_add_u32 m0, s14, 0x21000
s_add_u32 s18, s23, 0x8000
buffer_load_dwordx4 v1, s[56:59], s18 offen lds
ds_read_b128 v[72:75], v34 offset:0
ds_read_b64_tr_b16 v[76:77], v37 offset:18432
ds_read_b64_tr_b16 v[78:79], v37 offset:18688
ds_read_b128 v[84:87], v35 offset:0
ds_read_b64_tr_b16 v[88:89], v37 offset:19456
ds_read_b64_tr_b16 v[90:91], v37 offset:19712
s_add_u32 m0, s14, 0x22000
s_add_u32 s18, s23, 0x10000
buffer_load_dwordx4 v1, s[56:59], s18 offen lds
s_waitcnt lgkmcnt(9)
v_mfma_f32_32x32x16_bf16 v[96:111], v[20:23], v[16:19], 0
s_add_u32 m0, s14, 0x23000
s_add_u32 s18, s23, 0x18000
buffer_load_dwordx4 v1, s[56:59], s18 offen lds
s_waitcnt lgkmcnt(6)
v_mfma_f32_32x32x16_bf16 v[96:111], v[28:31], v[24:27], v[96:111]
s_add_u32 m0, s14, 0x24000
s_add_u32 s18, s24, 0x0
buffer_load_dwordx4 v2, s[60:63], s18 offen lds
s_waitcnt lgkmcnt(3)
v_mfma_f32_32x32x16_bf16 v[96:111], v[76:79], v[72:75], v[96:111]
s_add_u32 m0, s14, 0x25000
s_add_u32 s18, s24, 0x400
buffer_load_dwordx4 v2, s[60:63], s18 offen lds
s_waitcnt lgkmcnt(0)
v_mfma_f32_32x32x16_bf16 v[96:111], v[88:91], v[84:87], v[96:111]
s_add_u32 m0, s14, 0x26000
s_add_u32 s18, s24, 0x800
buffer_load_dwordx4 v2, s[60:63], s18 offen lds
s_barrier
s_add_u32 s22, s87, 5
s_and_b32 s22, s22, 7
s_lshl_b32 s23, s22, 7
s_add_u32 s23, s23, s12
s_mul_i32 s24, s22, 0x30000
s_add_u32 s24, s24, s13
s_add_u32 m0, s14, 0x0
s_add_u32 s18, s23, 0x0
buffer_load_dwordx4 v1, s[56:59], s18 offen lds
ds_read_b128 v[16:19], v32 offset:32768
ds_read_b64_tr_b16 v[20:21], v37 offset:49152
ds_read_b64_tr_b16 v[22:23], v37 offset:49408
ds_read_b128 v[24:27], v33 offset:32768
ds_read_b64_tr_b16 v[28:29], v37 offset:50176
ds_read_b64_tr_b16 v[30:31], v37 offset:50432
s_add_u32 m0, s14, 0x1000
s_add_u32 s18, s23, 0x8000
buffer_load_dwordx4 v1, s[56:59], s18 offen lds
ds_read_b128 v[72:75], v34 offset:32768
ds_read_b64_tr_b16 v[76:77], v37 offset:51200
ds_read_b64_tr_b16 v[78:79], v37 offset:51456
ds_read_b128 v[84:87], v35 offset:32768
ds_read_b64_tr_b16 v[88:89], v37 offset:52224
ds_read_b64_tr_b16 v[90:91], v37 offset:52480
s_add_u32 m0, s14, 0x2000
s_add_u32 s18, s23, 0x10000
buffer_load_dwordx4 v1, s[56:59], s18 offen lds
s_waitcnt lgkmcnt(9)
v_mfma_f32_32x32x16_bf16 v[96:111], v[20:23], v[16:19], v[96:111]
s_add_u32 m0, s14, 0x3000
s_add_u32 s18, s23, 0x18000
buffer_load_dwordx4 v1, s[56:59], s18 offen lds
s_waitcnt lgkmcnt(6)
v_mfma_f32_32x32x16_bf16 v[96:111], v[28:31], v[24:27], v[96:111]
s_add_u32 m0, s14, 0x4000
s_add_u32 s18, s24, 0x0
buffer_load_dwordx4 v2, s[60:63], s18 offen lds
s_waitcnt lgkmcnt(3)
v_mfma_f32_32x32x16_bf16 v[96:111], v[76:79], v[72:75], v[96:111]
s_add_u32 m0, s14, 0x5000
s_add_u32 s18, s24, 0x400
buffer_load_dwordx4 v2, s[60:63], s18 offen lds
s_waitcnt lgkmcnt(0)
v_mfma_f32_32x32x16_bf16 v[96:111], v[88:91], v[84:87], v[96:111]
s_add_u32 m0, s14, 0x6000
s_add_u32 s18, s24, 0x800
buffer_load_dwordx4 v2, s[60:63], s18 offen lds
s_barrier
v_add_u32 v32, 0x10000, v32
v_add_u32 v33, 0x10000, v33
v_add_u32 v34, 0x10000, v34
v_add_u32 v35, 0x10000, v35
v_add_u32 v37, 0x10000, v37
s_add_u32 s22, s87, 6
s_and_b32 s22, s22, 7
s_lshl_b32 s23, s22, 7
s_add_u32 s23, s23, s12
s_mul_i32 s24, s22, 0x30000
s_add_u32 s24, s24, s13
s_add_u32 m0, s14, 0x8000
s_add_u32 s18, s23, 0x0
buffer_load_dwordx4 v1, s[56:59], s18 offen lds
ds_read_b128 v[16:19], v32 offset:0
ds_read_b64_tr_b16 v[20:21], v37 offset:16384
ds_read_b64_tr_b16 v[22:23], v37 offset:16640
ds_read_b128 v[24:27], v33 offset:0
ds_read_b64_tr_b16 v[28:29], v37 offset:17408
ds_read_b64_tr_b16 v[30:31], v37 offset:17664
s_add_u32 m0, s14, 0x9000
s_add_u32 s18, s23, 0x8000
buffer_load_dwordx4 v1, s[56:59], s18 offen lds
ds_read_b128 v[72:75], v34 offset:0
ds_read_b64_tr_b16 v[76:77], v37 offset:18432
ds_read_b64_tr_b16 v[78:79], v37 offset:18688
ds_read_b128 v[84:87], v35 offset:0
ds_read_b64_tr_b16 v[88:89], v37 offset:19456
ds_read_b64_tr_b16 v[90:91], v37 offset:19712
s_add_u32 m0, s14, 0xa000
s_add_u32 s18, s23, 0x10000
buffer_load_dwordx4 v1, s[56:59], s18 offen lds
s_waitcnt lgkmcnt(9)
v_mfma_f32_32x32x16_bf16 v[96:111], v[20:23], v[16:19], v[96:111]
s_add_u32 m0, s14, 0xb000
s_add_u32 s18, s23, 0x18000
buffer_load_dwordx4 v1, s[56:59], s18 offen lds
s_waitcnt lgkmcnt(6)
v_mfma_f32_32x32x16_bf16 v[96:111], v[28:31], v[24:27], v[96:111]
s_add_u32 m0, s14, 0xc000
s_add_u32 s18, s24, 0x0
buffer_load_dwordx4 v2, s[60:63], s18 offen lds
s_waitcnt lgkmcnt(3)
v_mfma_f32_32x32x16_bf16 v[96:111], v[76:79], v[72:75], v[96:111]
s_add_u32 m0, s14, 0xd000
s_add_u32 s18, s24, 0x400
buffer_load_dwordx4 v2, s[60:63], s18 offen lds
s_waitcnt lgkmcnt(0)
v_mfma_f32_32x32x16_bf16 v[96:111], v[88:91], v[84:87], v[96:111]
s_add_u32 m0, s14, 0xe000
s_add_u32 s18, s24, 0x800
buffer_load_dwordx4 v2, s[60:63], s18 offen lds
s_barrier
s_add_u32 s22, s87, 7
s_and_b32 s22, s22, 7
s_lshl_b32 s23, s22, 7
s_add_u32 s23, s23, s12
s_mul_i32 s24, s22, 0x30000
s_add_u32 s24, s24, s13
s_add_u32 m0, s14, 0x10000
s_add_u32 s18, s23, 0x0
buffer_load_dwordx4 v1, s[56:59], s18 offen lds
ds_read_b128 v[16:19], v32 offset:32768
ds_read_b64_tr_b16 v[20:21], v37 offset:49152
ds_read_b64_tr_b16 v[22:23], v37 offset:49408
ds_read_b128 v[24:27], v33 offset:32768
ds_read_b64_tr_b16 v[28:29], v37 offset:50176
ds_read_b64_tr_b16 v[30:31], v37 offset:50432
s_add_u32 m0, s14, 0x11000
s_add_u32 s18, s23, 0x8000
buffer_load_dwordx4 v1, s[56:59], s18 offen lds
ds_read_b128 v[72:75], v34 offset:32768
ds_read_b64_tr_b16 v[76:77], v37 offset:51200
ds_read_b64_tr_b16 v[78:79], v37 offset:51456
ds_read_b128 v[84:87], v35 offset:32768
ds_read_b64_tr_b16 v[88:89], v37 offset:52224
ds_read_b64_tr_b16 v[90:91], v37 offset:52480
s_add_u32 m0, s14, 0x12000
s_add_u32 s18, s23, 0x10000
buffer_load_dwordx4 v1, s[56:59], s18 offen lds
s_waitcnt lgkmcnt(9)
v_mfma_f32_32x32x16_bf16 v[96:111], v[20:23], v[16:19], v[96:111]
s_add_u32 m0, s14, 0x13000
s_add_u32 s18, s23, 0x18000
buffer_load_dwordx4 v1, s[56:59], s18 offen lds
s_waitcnt lgkmcnt(6)
v_mfma_f32_32x32x16_bf16 v[96:111], v[28:31], v[24:27], v[96:111]
s_add_u32 m0, s14, 0x14000
s_add_u32 s18, s24, 0x0
buffer_load_dwordx4 v2, s[60:63], s18 offen lds
s_waitcnt lgkmcnt(3)
v_mfma_f32_32x32x16_bf16 v[96:111], v[76:79], v[72:75], v[96:111]
s_add_u32 m0, s14, 0x15000
s_add_u32 s18, s24, 0x400
buffer_load_dwordx4 v2, s[60:63], s18 offen lds
s_waitcnt lgkmcnt(0)
v_mfma_f32_32x32x16_bf16 v[96:111], v[88:91], v[84:87], v[96:111]
s_add_u32 m0, s14, 0x16000
s_add_u32 s18, s24, 0x800
buffer_load_dwordx4 v2, s[60:63], s18 offen lds
s_waitcnt vmcnt(21)
s_barrier
v_add_u32 v32, 0x10000, v32
v_add_u32 v33, 0x10000, v33
v_add_u32 v34, 0x10000, v34
v_add_u32 v35, 0x10000, v35
v_add_u32 v37, 0x10000, v37
ds_read_b128 v[16:19], v32 offset:0
ds_read_b64_tr_b16 v[20:21], v37 offset:16384
ds_read_b64_tr_b16 v[22:23], v37 offset:16640
ds_read_b128 v[24:27], v33 offset:0
ds_read_b64_tr_b16 v[28:29], v37 offset:17408
ds_read_b64_tr_b16 v[30:31], v37 offset:17664
ds_read_b128 v[72:75], v34 offset:0
ds_read_b64_tr_b16 v[76:77], v37 offset:18432
ds_read_b64_tr_b16 v[78:79], v37 offset:18688
ds_read_b128 v[84:87], v35 offset:0
ds_read_b64_tr_b16 v[88:89], v37 offset:19456
ds_read_b64_tr_b16 v[90:91], v37 offset:19712
s_waitcnt lgkmcnt(9)
v_mfma_f32_32x32x16_bf16 v[96:111], v[20:23], v[16:19], v[96:111]
s_waitcnt lgkmcnt(6)
v_mfma_f32_32x32x16_bf16 v[96:111], v[28:31], v[24:27], v[96:111]
s_waitcnt lgkmcnt(3)
v_mfma_f32_32x32x16_bf16 v[96:111], v[76:79], v[72:75], v[96:111]
s_waitcnt lgkmcnt(0)
v_mfma_f32_32x32x16_bf16 v[96:111], v[88:91], v[84:87], v[96:111]
s_waitcnt vmcnt(14)
s_barrier
v_add_u32 v32, 0xfffe0000, v32
v_add_u32 v33, 0xfffe0000, v33
v_add_u32 v34, 0xfffe0000, v34
v_add_u32 v35, 0xfffe0000, v35
v_add_u32 v37, 0xfffe0000, v37
ds_read_b128 v[16:19], v32 offset:0
ds_read_b64_tr_b16 v[20:21], v37 offset:16384
ds_read_b64_tr_b16 v[22:23], v37 offset:16640
ds_read_b128 v[24:27], v33 offset:0
ds_read_b64_tr_b16 v[28:29], v37 offset:17408
ds_read_b64_tr_b16 v[30:31], v37 offset:17664
ds_read_b128 v[72:75], v34 offset:0
ds_read_b64_tr_b16 v[76:77], v37 offset:18432
ds_read_b64_tr_b16 v[78:79], v37 offset:18688
ds_read_b128 v[84:87], v35 offset:0
ds_read_b64_tr_b16 v[88:89], v37 offset:19456
ds_read_b64_tr_b16 v[90:91], v37 offset:19712
s_waitcnt lgkmcnt(9)
v_mfma_f32_32x32x16_bf16 v[96:111], v[20:23], v[16:19], v[96:111]
s_waitcnt lgkmcnt(6)
v_mfma_f32_32x32x16_bf16 v[96:111], v[28:31], v[24:27], v[96:111]
s_waitcnt lgkmcnt(3)
v_mfma_f32_32x32x16_bf16 v[96:111], v[76:79], v[72:75], v[96:111]
s_waitcnt lgkmcnt(0)
v_mfma_f32_32x32x16_bf16 v[96:111], v[88:91], v[84:87], v[96:111]
ds_read_b64_tr_b16 v[92:93], v5
ds_read_b64_tr_b16 v[94:95], v5 offset:128
s_waitcnt lgkmcnt(0)
v_cmp_gt_u32 vcc, 16, v36
s_nop 1
v_cndmask_b32 v240, 0, v92, vcc
v_cndmask_b32 v244, v92, 0, vcc
v_cndmask_b32 v241, 0, v93, vcc
v_cndmask_b32 v245, v93, 0, vcc
v_cndmask_b32 v242, 0, v94, vcc
v_cndmask_b32 v246, v94, 0, vcc
v_cndmask_b32 v243, 0, v95, vcc
v_cndmask_b32 v247, v95, 0, vcc
s_waitcnt vmcnt(7)
s_barrier
v_lshrrev_b32 v81, 3, v0
v_lshrrev_b32 v82, 2, v0
v_and_b32 v82, 4, v82
v_and_b32 v83, 7, v0
v_xor_b32 v82, v82, v83
v_lshlrev_b32 v82, 4, v82
v_lshl_or_b32 v81, v81, 10, v82
s_mov_b32 s92, s38
s_mov_b32 s93, s39
s_mov_b32 s94, 0x80000
s_mov_b32 s95, 0x00020000
s_lshr_b32 s19, s3, 1
s_and_b32 s20, s3, 1
s_lshl_b32 s21, s19, 13
s_lshl_b32 s22, s20, 17
s_add_u32 s21, s21, s22
s_lshl_b32 s22, s7, 7
s_add_u32 s21, s21, s22
s_lshl_b32 s22, s19, 10
s_lshl_b32 s23, s20, 14
s_add_u32 s22, s22, s23
s_add_u32 m0, s22, 0x0
s_add_u32 s18, s21, 0x0
buffer_load_dwordx4 v81, s[92:95], s18 offen lds
ds_read_b128 v[16:19], v32 offset:32768
ds_read_b64_tr_b16 v[20:21], v37 offset:49152
ds_read_b64_tr_b16 v[22:23], v37 offset:49408
ds_read_b128 v[24:27], v33 offset:32768
ds_read_b64_tr_b16 v[28:29], v37 offset:50176
ds_read_b64_tr_b16 v[30:31], v37 offset:50432
s_add_u32 m0, s22, 0x800
s_add_u32 s18, s21, 0x4000
buffer_load_dwordx4 v81, s[92:95], s18 offen lds
ds_read_b128 v[72:75], v34 offset:32768
ds_read_b64_tr_b16 v[76:77], v37 offset:51200
ds_read_b64_tr_b16 v[78:79], v37 offset:51456
ds_read_b128 v[84:87], v35 offset:32768
ds_read_b64_tr_b16 v[88:89], v37 offset:52224
ds_read_b64_tr_b16 v[90:91], v37 offset:52480
s_add_u32 m0, s22, 0x1000
s_add_u32 s18, s21, 0x8000
buffer_load_dwordx4 v81, s[92:95], s18 offen lds
s_waitcnt lgkmcnt(9)
v_mfma_f32_32x32x16_bf16 v[96:111], v[20:23], v[16:19], v[96:111]
s_add_u32 m0, s22, 0x1800
s_add_u32 s18, s21, 0xc000
buffer_load_dwordx4 v81, s[92:95], s18 offen lds
s_waitcnt lgkmcnt(6)
v_mfma_f32_32x32x16_bf16 v[96:111], v[28:31], v[24:27], v[96:111]
s_add_u32 m0, s22, 0x2000
s_add_u32 s18, s21, 0x10000
buffer_load_dwordx4 v81, s[92:95], s18 offen lds
s_waitcnt lgkmcnt(3)
v_mfma_f32_32x32x16_bf16 v[96:111], v[76:79], v[72:75], v[96:111]
s_add_u32 m0, s22, 0x2800
s_add_u32 s18, s21, 0x14000
buffer_load_dwordx4 v81, s[92:95], s18 offen lds
s_waitcnt lgkmcnt(0)
v_mfma_f32_32x32x16_bf16 v[96:111], v[88:91], v[84:87], v[96:111]
s_add_u32 m0, s22, 0x3000
s_add_u32 s18, s21, 0x18000
buffer_load_dwordx4 v81, s[92:95], s18 offen lds
s_add_u32 m0, s22, 0x3800
s_add_u32 s18, s21, 0x1c000
buffer_load_dwordx4 v81, s[92:95], s18 offen lds
s_waitcnt vmcnt(8)
s_barrier
v_add_u32 v32, 0x10000, v32
v_add_u32 v33, 0x10000, v33
v_add_u32 v34, 0x10000, v34
v_add_u32 v35, 0x10000, v35
v_add_u32 v37, 0x10000, v37
ds_read_b128 v[16:19], v32 offset:0
ds_read_b64_tr_b16 v[20:21], v37 offset:16384
ds_read_b64_tr_b16 v[22:23], v37 offset:16640
ds_read_b128 v[24:27], v33 offset:0
ds_read_b64_tr_b16 v[28:29], v37 offset:17408
ds_read_b64_tr_b16 v[30:31], v37 offset:17664
ds_read_b128 v[72:75], v34 offset:0
ds_read_b64_tr_b16 v[76:77], v37 offset:18432
ds_read_b64_tr_b16 v[78:79], v37 offset:18688
ds_read_b128 v[84:87], v35 offset:0
ds_read_b64_tr_b16 v[88:89], v37 offset:19456
ds_read_b64_tr_b16 v[90:91], v37 offset:19712
s_waitcnt lgkmcnt(9)
v_mfma_f32_32x32x16_bf16 v[96:111], v[20:23], v[16:19], v[96:111]
s_waitcnt lgkmcnt(6)
v_mfma_f32_32x32x16_bf16 v[96:111], v[28:31], v[24:27], v[96:111]
s_waitcnt lgkmcnt(3)
v_mfma_f32_32x32x16_bf16 v[96:111], v[76:79], v[72:75], v[96:111]
s_waitcnt lgkmcnt(0)
v_mfma_f32_32x32x16_bf16 v[96:111], v[88:91], v[84:87], v[96:111]
ds_write_b32 v253, v254 offset:256
v_mov_b32 v38, 0
global_load_dword v39, v38, s[52:53] offset:128 sc1
s_setprio 3
s_nop 7
v_cvt_pk_bf16_f32 v16, v96, v97
v_cvt_pk_bf16_f32 v17, v98, v99
v_cvt_pk_bf16_f32 v18, v100, v101
v_cvt_pk_bf16_f32 v19, v102, v103
v_cvt_pk_bf16_f32 v20, v104, v105
v_cvt_pk_bf16_f32 v21, v106, v107
v_cvt_pk_bf16_f32 v22, v108, v109
v_cvt_pk_bf16_f32 v23, v110, v111
v_lshlrev_b32 v28, 4, v0
s_lshl_b32 s18, s8, 2
v_mfma_f32_32x32x16_bf16 v[96:111], v[240:243], v[16:19], 0
v_mfma_f32_32x32x16_bf16 v[96:111], v[244:247], v[20:23], v[96:111]
s_add_u32 s18, s18, s3
s_lshl_b32 s30, s18, 16
s_lshl_b32 s19, s9, 12
s_add_u32 s30, s30, s19
s_add_u32 s30, s30, 0x100000
s_lshl_b32 s19, s18, 1
s_lshr_b32 s20, s9, 3
s_add_u32 s19, s19, s20
s_lshl_b32 s19, s19, 7
s_add_u32 s31, s19, 0x1010000
s_nop 1
v_max3_f32 v56, v96, v97, v98
v_min3_f32 v60, v96, v97, v98
v_max3_f32 v58, v104, v105, v106
v_min3_f32 v62, v104, v105, v106
v_max3_f32 v56, v56, v99, v100
v_min3_f32 v60, v60, v99, v100
v_max3_f32 v58, v58, v107, v108
v_min3_f32 v62, v62, v107, v108
v_max3_f32 v56, v56, v101, v102
v_min3_f32 v60, v60, v101, v102
v_max3_f32 v58, v58, v109, v110
v_min3_f32 v62, v62, v109, v110
v_max_f32 v56, v56, v103
v_min_f32 v60, v60, v103
v_max_f32 v58, v58, v111
v_min_f32 v62, v62, v111
v_mov_b32 v57, v56
v_mov_b32 v61, v60
v_mov_b32 v59, v58
v_mov_b32 v63, v62
v_permlane32_swap_b32 v56, v57
v_permlane32_swap_b32 v60, v61
v_permlane32_swap_b32 v58, v59
v_permlane32_swap_b32 v62, v63
v_max_f32 v56, v56, v57
v_min_f32 v60, v60, v61
v_max_f32 v58, v58, v59
v_min_f32 v62, v62, v63
v_mul_f32 v56, s29, v56
v_mul_f32 v60, s28, v60
v_mul_f32 v58, s29, v58
v_mul_f32 v62, s28, v62
v_pk_fma_f32 v[64:65], v[96:97], s[28:29], v[60:61] op_sel_hi:[1,0,0] neg_lo:[1,0,0] neg_hi:[1,0,0]
v_pk_fma_f32 v[96:97], v[96:97], s[28:29], v[56:57] op_sel_hi:[1,0,0]
v_pk_fma_f32 v[66:67], v[98:99], s[28:29], v[60:61] op_sel_hi:[1,0,0] neg_lo:[1,0,0] neg_hi:[1,0,0]
v_pk_fma_f32 v[98:99], v[98:99], s[28:29], v[56:57] op_sel_hi:[1,0,0]
v_pk_fma_f32 v[68:69], v[100:101], s[28:29], v[60:61] op_sel_hi:[1,0,0] neg_lo:[1,0,0] neg_hi:[1,0,0]
v_pk_fma_f32 v[100:101], v[100:101], s[28:29], v[56:57] op_sel_hi:[1,0,0]
v_pk_fma_f32 v[70:71], v[102:103], s[28:29], v[60:61] op_sel_hi:[1,0,0] neg_lo:[1,0,0] neg_hi:[1,0,0]
v_pk_fma_f32 v[102:103], v[102:103], s[28:29], v[56:57] op_sel_hi:[1,0,0]
v_pk_fma_f32 v[72:73], v[104:105], s[28:29], v[62:63] op_sel_hi:[1,0,0] neg_lo:[1,0,0] neg_hi:[1,0,0]
v_pk_fma_f32 v[104:105], v[104:105], s[28:29], v[58:59] op_sel_hi:[1,0,0]
v_pk_fma_f32 v[74:75], v[106:107], s[28:29], v[62:63] op_sel_hi:[1,0,0] neg_lo:[1,0,0] neg_hi:[1,0,0]
v_pk_fma_f32 v[106:107], v[106:107], s[28:29], v[58:59] op_sel_hi:[1,0,0]
v_pk_fma_f32 v[76:77], v[108:109], s[28:29], v[62:63] op_sel_hi:[1,0,0] neg_lo:[1,0,0] neg_hi:[1,0,0]
v_pk_fma_f32 v[108:109], v[108:109], s[28:29], v[58:59] op_sel_hi:[1,0,0]
v_pk_fma_f32 v[78:79], v[110:111], s[28:29], v[62:63] op_sel_hi:[1,0,0] neg_lo:[1,0,0] neg_hi:[1,0,0]
v_pk_fma_f32 v[110:111], v[110:111], s[28:29], v[58:59] op_sel_hi:[1,0,0]
v_exp_f32 v64, v64
v_exp_f32 v96, v96
v_exp_f32 v65, v65
v_exp_f32 v97, v97
v_exp_f32 v66, v66
v_exp_f32 v98, v98
v_exp_f32 v67, v67
v_exp_f32 v99, v99
v_exp_f32 v68, v68
v_exp_f32 v100, v100
v_exp_f32 v69, v69
v_exp_f32 v101, v101
v_exp_f32 v70, v70
v_exp_f32 v102, v102
v_exp_f32 v71, v71
v_exp_f32 v103, v103
v_exp_f32 v72, v72
v_exp_f32 v104, v104
v_exp_f32 v73, v73
v_exp_f32 v105, v105
v_exp_f32 v74, v74
v_exp_f32 v106, v106
v_exp_f32 v75, v75
v_exp_f32 v107, v107
v_exp_f32 v76, v76
v_exp_f32 v108, v108
v_exp_f32 v77, v77
v_exp_f32 v109, v109
v_exp_f32 v78, v78
v_exp_f32 v110, v110
v_exp_f32 v79, v79
v_exp_f32 v111, v111
v_pk_add_f32 v[56:57], v[96:97], v[98:99]
v_pk_add_f32 v[60:61], v[64:65], v[66:67]
v_pk_add_f32 v[58:59], v[104:105], v[106:107]
v_pk_add_f32 v[62:63], v[72:73], v[74:75]
v_pk_add_f32 v[56:57], v[56:57], v[100:101]
v_pk_add_f32 v[60:61], v[60:61], v[68:69]
v_pk_add_f32 v[58:59], v[58:59], v[108:109]
v_pk_add_f32 v[62:63], v[62:63], v[76:77]
v_pk_add_f32 v[56:57], v[56:57], v[102:103]
v_pk_add_f32 v[60:61], v[60:61], v[70:71]
v_pk_add_f32 v[58:59], v[58:59], v[110:111]
v_pk_add_f32 v[62:63], v[62:63], v[78:79]
v_add_f32 v56, v56, v57
v_add_f32 v60, v60, v61
v_add_f32 v58, v58, v59
v_add_f32 v62, v62, v63
v_mov_b32 v57, v56
v_mov_b32 v61, v60
v_mov_b32 v59, v58
v_mov_b32 v63, v62
v_permlane32_swap_b32 v56, v57
v_permlane32_swap_b32 v60, v61
v_permlane32_swap_b32 v58, v59
v_permlane32_swap_b32 v62, v63
v_add_f32 v56, v56, v57
v_add_f32 v60, v60, v61
v_add_f32 v58, v58, v59
v_add_f32 v62, v62, v63
v_rcp_f32 v56, v56
v_rcp_f32 v60, v60
v_rcp_f32 v58, v58
v_rcp_f32 v62, v62
v_pk_mul_f32 v[96:97], v[96:97], v[56:57] op_sel_hi:[1,0]
v_pk_mul_f32 v[64:65], v[64:65], v[60:61] op_sel_hi:[1,0]
v_pk_mul_f32 v[98:99], v[98:99], v[56:57] op_sel_hi:[1,0]
v_pk_mul_f32 v[66:67], v[66:67], v[60:61] op_sel_hi:[1,0]
v_pk_mul_f32 v[100:101], v[100:101], v[56:57] op_sel_hi:[1,0]
v_pk_mul_f32 v[68:69], v[68:69], v[60:61] op_sel_hi:[1,0]
v_pk_mul_f32 v[102:103], v[102:103], v[56:57] op_sel_hi:[1,0]
v_pk_mul_f32 v[70:71], v[70:71], v[60:61] op_sel_hi:[1,0]
v_pk_mul_f32 v[104:105], v[104:105], v[58:59] op_sel_hi:[1,0]
v_pk_mul_f32 v[72:73], v[72:73], v[62:63] op_sel_hi:[1,0]
v_pk_mul_f32 v[106:107], v[106:107], v[58:59] op_sel_hi:[1,0]
v_pk_mul_f32 v[74:75], v[74:75], v[62:63] op_sel_hi:[1,0]
v_pk_mul_f32 v[108:109], v[108:109], v[58:59] op_sel_hi:[1,0]
v_pk_mul_f32 v[76:77], v[76:77], v[62:63] op_sel_hi:[1,0]
v_pk_mul_f32 v[110:111], v[110:111], v[58:59] op_sel_hi:[1,0]
v_pk_mul_f32 v[78:79], v[78:79], v[62:63] op_sel_hi:[1,0]
v_cvt_pk_bf16_f32 v96, v96, v97
v_cvt_pk_bf16_f32 v97, v98, v99
v_cvt_pk_bf16_f32 v98, v100, v101
v_cvt_pk_bf16_f32 v99, v102, v103
v_cvt_pk_bf16_f32 v104, v104, v105
v_cvt_pk_bf16_f32 v105, v106, v107
v_cvt_pk_bf16_f32 v106, v108, v109
v_cvt_pk_bf16_f32 v107, v110, v111
v_cvt_pk_bf16_f32 v100, v64, v65
v_cvt_pk_bf16_f32 v101, v66, v67
v_cvt_pk_bf16_f32 v102, v68, v69
v_cvt_pk_bf16_f32 v103, v70, v71
v_cvt_pk_bf16_f32 v108, v72, v73
v_cvt_pk_bf16_f32 v109, v74, v75
v_cvt_pk_bf16_f32 v110, v76, v77
v_cvt_pk_bf16_f32 v111, v78, v79
buffer_store_dwordx4 v[96:99], v28, s[76:79], s30 offen offset:0 sc1
buffer_store_dwordx4 v[100:103], v28, s[76:79], s30 offen offset:1024 sc1
buffer_store_dwordx4 v[104:107], v28, s[76:79], s30 offen offset:2048 sc1
buffer_store_dwordx4 v[108:111], v28, s[76:79], s30 offen offset:3072 sc1
v_lshrrev_b32 v10, 5, v0
v_and_b32 v12, 15, v4
v_xor_b32 v12, v12, v10
v_lshlrev_b32 v12, 4, v12
v_lshl_or_b32 v12, v4, 8, v12
s_lshr_b32 s27, s3, 1
s_lshl_b32 s27, s27, 13
s_add_u32 s27, s27, 0x18000
v_add_u32 v72, s27, v12
v_xor_b32 v73, 0x20, v72
v_xor_b32 v74, 0x40, v72
v_xor_b32 v75, 0x60, v72
v_xor_b32 v76, 0x80, v72
v_xor_b32 v77, 0xa0, v72
v_xor_b32 v78, 0xc0, v72
v_xor_b32 v79, 0xe0, v72
s_lshl_b32 s27, s3, 11
s_add_u32 s27, s27, 0x1a000
v_add_u32 v29, s27, v28
s_setprio 3
FW1:
ds_read_b32 v255, v252 offset:352
s_waitcnt lgkmcnt(0)
v_cmp_eq_u32 vcc, 0, v255
s_nop 3
s_cbranch_vccz FW1_D
s_branch FW1
FW1_D:
ds_read_b128 v[16:19], v72 offset:0
ds_read_b128 v[20:23], v73 offset:0
ds_read_b128 v[24:27], v74 offset:0
ds_read_b128 v[84:87], v75 offset:0
s_waitcnt lgkmcnt(3)
v_mfma_f32_32x32x16_bf16 v[96:111], v[16:19], v[112:115], 0
ds_read_b128 v[88:91], v76 offset:0
s_waitcnt lgkmcnt(3)
v_mfma_f32_32x32x16_bf16 v[96:111], v[20:23], v[116:119], v[96:111]
ds_read_b128 v[92:95], v77 offset:0
s_waitcnt lgkmcnt(3)
v_mfma_f32_32x32x16_bf16 v[96:111], v[24:27], v[120:123], v[96:111]
ds_read_b128 v[16:19], v78 offset:0
s_waitcnt lgkmcnt(3)
v_mfma_f32_32x32x16_bf16 v[96:111], v[84:87], v[124:127], v[96:111]
ds_read_b128 v[20:23], v79 offset:0
s_waitcnt lgkmcnt(3)
v_mfma_f32_32x32x16_bf16 v[96:111], v[88:91], v[128:131], v[96:111]
ds_read_b128 v[24:27], v72 offset:16384
s_waitcnt lgkmcnt(3)
v_mfma_f32_32x32x16_bf16 v[96:111], v[92:95], v[132:135], v[96:111]
ds_read_b128 v[84:87], v73 offset:16384
s_waitcnt lgkmcnt(3)
v_mfma_f32_32x32x16_bf16 v[96:111], v[16:19], v[136:139], v[96:111]
ds_read_b128 v[88:91], v74 offset:16384
s_waitcnt lgkmcnt(3)
v_mfma_f32_32x32x16_bf16 v[96:111], v[20:23], v[140:143], v[96:111]
ds_read_b128 v[92:95], v75 offset:16384
s_waitcnt lgkmcnt(3)
v_mfma_f32_32x32x16_bf16 v[96:111], v[24:27], v[144:147], v[96:111]
ds_read_b128 v[16:19], v76 offset:16384
s_waitcnt lgkmcnt(3)
v_mfma_f32_32x32x16_bf16 v[96:111], v[84:87], v[148:151], v[96:111]
ds_read_b128 v[20:23], v77 offset:16384
s_waitcnt lgkmcnt(3)
v_mfma_f32_32x32x16_bf16 v[96:111], v[88:91], v[152:155], v[96:111]
ds_read_b128 v[24:27], v78 offset:16384
s_waitcnt lgkmcnt(3)
v_mfma_f32_32x32x16_bf16 v[96:111], v[92:95], v[156:159], v[96:111]
ds_read_b128 v[84:87], v79 offset:16384
s_waitcnt lgkmcnt(3)
v_mfma_f32_32x32x16_bf16 v[96:111], v[16:19], v[160:163], v[96:111]
s_waitcnt lgkmcnt(2)
v_mfma_f32_32x32x16_bf16 v[96:111], v[20:23], v[164:167], v[96:111]
s_waitcnt lgkmcnt(1)
v_mfma_f32_32x32x16_bf16 v[96:111], v[24:27], v[168:171], v[96:111]
s_waitcnt lgkmcnt(0)
v_mfma_f32_32x32x16_bf16 v[96:111], v[84:87], v[172:175], v[96:111]
s_waitcnt lgkmcnt(0)
ds_write_b32 v253, v254 offset:32
s_nop 8
FW2:
ds_read_b32 v255, v252 offset:32
s_waitcnt lgkmcnt(0)
v_cmp_eq_u32 vcc, 0, v255
s_nop 3
s_cbranch_vccz FW2_D
s_branch FW2
FW2_D:
ds_read_b128 v[88:91], v72 offset:32768
ds_read_b128 v[92:95], v73 offset:32768
ds_read_b128 v[16:19], v74 offset:32768
ds_read_b128 v[20:23], v75 offset:32768
s_waitcnt lgkmcnt(3)
v_mfma_f32_32x32x16_bf16 v[96:111], v[88:91], v[176:179], v[96:111]
ds_read_b128 v[24:27], v76 offset:32768
s_waitcnt lgkmcnt(3)
v_mfma_f32_32x32x16_bf16 v[96:111], v[92:95], v[180:183], v[96:111]
ds_read_b128 v[84:87], v77 offset:32768
s_waitcnt lgkmcnt(3)
v_mfma_f32_32x32x16_bf16 v[96:111], v[16:19], v[184:187], v[96:111]
ds_read_b128 v[88:91], v78 offset:32768
s_waitcnt lgkmcnt(3)
v_mfma_f32_32x32x16_bf16 v[96:111], v[20:23], v[188:191], v[96:111]
ds_read_b128 v[92:95], v79 offset:32768
s_waitcnt lgkmcnt(3)
v_mfma_f32_32x32x16_bf16 v[96:111], v[24:27], v[192:195], v[96:111]
ds_read_b128 v[16:19], v72 offset:49152
s_waitcnt lgkmcnt(3)
v_mfma_f32_32x32x16_bf16 v[96:111], v[84:87], v[196:199], v[96:111]
ds_read_b128 v[20:23], v73 offset:49152
s_waitcnt lgkmcnt(3)
v_mfma_f32_32x32x16_bf16 v[96:111], v[88:91], v[200:203], v[96:111]
ds_read_b128 v[24:27], v74 offset:49152
s_waitcnt lgkmcnt(3)
v_mfma_f32_32x32x16_bf16 v[96:111], v[92:95], v[204:207], v[96:111]
ds_read_b128 v[84:87], v75 offset:49152
s_waitcnt lgkmcnt(3)
v_mfma_f32_32x32x16_bf16 v[96:111], v[16:19], v[208:211], v[96:111]
ds_read_b128 v[88:91], v76 offset:49152
s_waitcnt lgkmcnt(3)
v_mfma_f32_32x32x16_bf16 v[96:111], v[20:23], v[212:215], v[96:111]
ds_read_b128 v[92:95], v77 offset:49152
s_waitcnt lgkmcnt(3)
v_mfma_f32_32x32x16_bf16 v[96:111], v[24:27], v[216:219], v[96:111]
ds_read_b128 v[16:19], v78 offset:49152
s_waitcnt lgkmcnt(3)
v_mfma_f32_32x32x16_bf16 v[96:111], v[84:87], v[220:223], v[96:111]
ds_read_b128 v[20:23], v79 offset:49152
s_waitcnt lgkmcnt(3)
v_mfma_f32_32x32x16_bf16 v[96:111], v[88:91], v[224:227], v[96:111]
s_waitcnt lgkmcnt(2)
v_mfma_f32_32x32x16_bf16 v[96:111], v[92:95], v[228:231], v[96:111]
s_waitcnt lgkmcnt(1)
v_mfma_f32_32x32x16_bf16 v[96:111], v[16:19], v[232:235], v[96:111]
s_waitcnt lgkmcnt(0)
v_mfma_f32_32x32x16_bf16 v[96:111], v[20:23], v[236:239], v[96:111]
s_waitcnt vmcnt(0)
s_mov_b32 s21, 0
s_nop 8
EPH:
v_readfirstlane_b32 s20, v39
s_nop 3
s_cmp_lg_u32 s20, 0
s_cbranch_scc1 EPH_OK
s_add_u32 s21, s21, 1
s_cmp_gt_u32 s21, 0x30d40
s_cbranch_scc1 EPH_OK
global_load_dword v39, v38, s[52:53] offset:128 sc1
s_waitcnt vmcnt(0)
s_branch EPH
EPH_OK:
v_mov_b32 v39, 1
s_mov_b64 exec, 1
buffer_atomic_add v39, v38, s[76:79], s31 offen
s_mov_b64 exec, -1
ds_write_b32 v253, v254 offset:288
v_xor_b32 v30, 0x1000, v29
v_xor_b32 v14, 8, v253
v_cvt_pk_bf16_f32 v112, v96, v97
v_cvt_pk_bf16_f32 v113, v98, v99
v_cvt_pk_bf16_f32 v114, v100, v101
v_cvt_pk_bf16_f32 v115, v102, v103
v_cvt_pk_bf16_f32 v116, v104, v105
v_cvt_pk_bf16_f32 v117, v106, v107
v_cvt_pk_bf16_f32 v118, v108, v109
v_cvt_pk_bf16_f32 v119, v110, v111
ds_write_b128 v29, v[112:115]
ds_write_b128 v29, v[116:119] offset:1024
ds_write_b32 v253, v254 offset:48
v_mfma_f32_32x32x16_bf16 v[136:151], v[112:115], v[40:43], 0
v_mfma_f32_32x32x16_bf16 v[136:151], v[116:119], v[44:47], v[136:151]
v_lshrrev_b32 v11, 5, v0
v_lshrrev_b32 v12, 2, v0
v_and_b32 v12, 3, v12
v_xor_b32 v11, v11, v12
v_lshlrev_b32 v11, 4, v11
v_lshl_or_b32 v11, v36, 6, v11
s_xor_b32 s18, s3, 2
s_lshl_b32 s18, s18, 11
s_add_u32 s18, s18, 0x1a000
v_add_u32 v11, s18, v11
v_xor_b32 v12, 32, v11
s_nop 0
FW3:
ds_read_b32 v255, v14 offset:48
s_waitcnt lgkmcnt(0)
v_cmp_eq_u32 vcc, 0, v255
s_nop 3
s_cbranch_vccz FW3_D
s_branch FW3
FW3_D:
ds_read_b128 v[120:123], v30
ds_read_b128 v[124:127], v30 offset:1024
v_lshrrev_b32 v13, 3, v0
v_and_b32 v10, 3, v0
v_lshrrev_b32 v14, 5, v0
v_xor_b32 v10, v10, v14
v_lshlrev_b32 v10, 4, v10
v_lshl_or_b32 v10, v13, 6, v10
v_and_b32 v14, 4, v0
v_lshl_or_b32 v10, v14, 9, v10
s_and_b32 s18, s3, 2
s_xor_b32 s18, s18, 2
s_lshl_b32 s18, s18, 11
s_and_b32 s19, s3, 1
s_lshl_b32 s19, s19, 10
s_add_u32 s18, s18, s19
s_add_u32 s18, s18, 0x1a000
v_add_u32 v10, s18, v10
v_add_u32 v14, 0x200, v10
v_xor_b32 v14, 32, v14
v_and_b32 v30, 7, v0
s_waitcnt lgkmcnt(1)
v_mfma_f32_32x32x16_bf16 v[136:151], v[120:123], v[48:51], v[136:151]
s_waitcnt lgkmcnt(0)
v_mfma_f32_32x32x16_bf16 v[136:151], v[124:127], v[52:55], v[136:151]
v_lshlrev_b32 v30, 4, v30
v_lshl_or_b32 v30, v13, 10, v30
s_lshl_b32 s18, s10, 16
s_lshl_b32 s19, s7, 7
s_add_u32 s18, s18, s19
s_lshl_b32 s19, s3, 14
s_add_u32 s18, s18, s19
s_add_u32 s18, s18, 0x800000
s_nop 3
v_cvt_pk_bf16_f32 v112, v136, v137
v_cvt_pk_bf16_f32 v113, v138, v139
v_cvt_pk_bf16_f32 v114, v140, v141
v_cvt_pk_bf16_f32 v115, v142, v143
v_cvt_pk_bf16_f32 v116, v144, v145
v_cvt_pk_bf16_f32 v117, v146, v147
v_cvt_pk_bf16_f32 v118, v148, v149
v_cvt_pk_bf16_f32 v119, v150, v151
ds_write_b128 v11, v[112:115]
ds_write_b128 v12, v[116:119]
ds_write_b32 v253, v254 offset:64
FW4:
ds_read_b32 v255, v252 offset:64
s_waitcnt lgkmcnt(0)
v_cmp_eq_u32 vcc, 0, v255
s_nop 3
s_cbranch_vccz FW4_D
s_branch FW4
FW4_D:
ds_read_b128 v[112:115], v10
ds_read_b128 v[116:119], v14
s_waitcnt lgkmcnt(1)
buffer_store_dwordx4 v[112:115], v30, s[76:79], s18 offen sc1
s_waitcnt lgkmcnt(0)
s_add_u32 s18, s18, 0x2000
buffer_store_dwordx4 v[116:119], v30, s[76:79], s18 offen sc1
v_lshlrev_b32 v61, 11, v0
v_mov_b32 v62, 1
s_lshl_b32 s29, s7, 8
s_add_u32 s29, s29, 0x1020000
v_lshlrev_b32 v8, 4, v0
s_lshl_b32 s18, s3, 10
v_add_u32 v8, s18, v8
s_and_b32 s10, s3, 1
s_lshr_b32 s11, s3, 1
s_waitcnt vmcnt(0)
ds_write_b32 v253, v254 offset:96
s_cmp_lg_u32 s3, 0
s_cbranch_scc1 HARR_SKIP
FW5:
ds_read_b32 v255, v252 offset:96
s_waitcnt lgkmcnt(0)
v_cmp_eq_u32 vcc, 0, v255
s_nop 3
s_cbranch_vccz FW5_D
s_branch FW5
FW5_D:
s_mov_b64 exec, 0xf
buffer_atomic_add v62, v61, s[76:79], s29 offen
s_mov_b64 exec, -1
HARR_SKIP:
s_cmp_eq_u32 s5, 0
s_cselect_b32 s12, 1, 0
s_and_b32 s13, s12, s10
s_lshl_b32 s14, s13, 5
s_add_u32 s14, s14, s5
v_lshrrev_b32 v1, 2, v0
v_and_b32 v2, 3, v0
v_lshlrev_b32 v2, 4, v2
v_lshl_or_b32 v3, v1, 16, v2
v_lshrrev_b32 v10, 4, v0
v_lshrrev_b32 v11, 3, v0
v_and_b32 v11, 1, v11
v_lshl_or_b32 v10, v11, 3, v10
s_and_b32 s18, s3, 1
s_lshl_b32 s18, s18, 2
v_add_u32 v10, s18, v10
v_lshlrev_b32 v10, 4, v10
v_lshrrev_b32 v11, 2, v0
v_and_b32 v11, 1, v11
v_mul_u32_u24 v11, 544, v11
v_add_u32 v10, v10, v11
v_lshrrev_b32 v11, 1, v0
v_and_b32 v11, 1, v11
v_mul_u32_u24 v11, 272, v11
v_add_u32 v10, v10, v11
v_and_b32 v11, 1, v0
v_lshl_add_u32 v10, v11, 3, v10
s_lshr_b32 s18, s3, 1
s_and_b32 s18, s18, 1
s_mul_i32 s18, s18, 1088
s_add_u32 s18, s18, 0x1f800
v_add_u32 v10, s18, v10
s_mov_b32 s96, s50
s_mov_b32 s97, s51
s_mov_b32 s98, 0x400000
s_mov_b32 s99, 0x00020000
v_and_b32 v4, 31, v0
v_lshlrev_b32 v5, 6, v4
v_add_u32 v5, s14, v5
v_lshrrev_b32 v6, 5, v0
v_cvt_f32_u32 v112, v5
v_mul_f32 v112, 0x3a000000, v112
v_lshlrev_b32 v113, 3, v6
v_cvt_f32_u32 v113, v113
v_mul_f32 v113, v113, v112
v_add_f32 v114, 0x3e800000, v113
v_cos_f32 v116, v113
v_cos_f32 v124, v114
v_add_f32 v113, v113, v112
v_add_f32 v114, v114, v112
v_cos_f32 v117, v113
v_cos_f32 v125, v114
v_add_f32 v113, v113, v112
v_add_f32 v114, v114, v112
v_cos_f32 v118, v113
v_cos_f32 v126, v114
v_add_f32 v113, v113, v112
v_add_f32 v114, v114, v112
v_cos_f32 v119, v113
v_cos_f32 v127, v114
v_add_f32 v113, v113, v112
v_add_f32 v114, v114, v112
v_cos_f32 v120, v113
v_cos_f32 v128, v114
v_add_f32 v113, v113, v112
v_add_f32 v114, v114, v112
v_cos_f32 v121, v113
v_cos_f32 v129, v114
v_add_f32 v113, v113, v112
v_add_f32 v114, v114, v112
v_cos_f32 v122, v113
v_cos_f32 v130, v114
v_add_f32 v113, v113, v112
v_add_f32 v114, v114, v112
v_cos_f32 v123, v113
v_cos_f32 v131, v114
v_cvt_pk_bf16_f32 v16, v116, v117
v_cvt_pk_bf16_f32 v24, v124, v125
v_cvt_pk_bf16_f32 v17, v118, v119
v_cvt_pk_bf16_f32 v25, v126, v127
v_cvt_pk_bf16_f32 v18, v120, v121
v_cvt_pk_bf16_f32 v26, v128, v129
v_cvt_pk_bf16_f32 v19, v122, v123
v_cvt_pk_bf16_f32 v27, v130, v131
v_lshlrev_b32 v113, 3, v6
v_add_u32 v113, 16, v113
v_cvt_f32_u32 v113, v113
v_mul_f32 v113, v113, v112
v_add_f32 v114, 0x3e800000, v113
v_cos_f32 v116, v113
v_cos_f32 v124, v114
v_add_f32 v113, v113, v112
v_add_f32 v114, v114, v112
v_cos_f32 v117, v113
v_cos_f32 v125, v114
v_add_f32 v113, v113, v112
v_add_f32 v114, v114, v112
v_cos_f32 v118, v113
v_cos_f32 v126, v114
v_add_f32 v113, v113, v112
v_add_f32 v114, v114, v112
v_cos_f32 v119, v113
v_cos_f32 v127, v114
v_add_f32 v113, v113, v112
v_add_f32 v114, v114, v112
v_cos_f32 v120, v113
v_cos_f32 v128, v114
v_add_f32 v113, v113, v112
v_add_f32 v114, v114, v112
v_cos_f32 v121, v113
v_cos_f32 v129, v114
v_add_f32 v113, v113, v112
v_add_f32 v114, v114, v112
v_cos_f32 v122, v113
v_cos_f32 v130, v114
v_add_f32 v113, v113, v112
v_add_f32 v114, v114, v112
v_cos_f32 v123, v113
v_cos_f32 v131, v114
v_cvt_pk_bf16_f32 v20, v116, v117
v_cvt_pk_bf16_f32 v28, v124, v125
v_cvt_pk_bf16_f32 v21, v118, v119
v_cvt_pk_bf16_f32 v29, v126, v127
v_cvt_pk_bf16_f32 v22, v120, v121
v_cvt_pk_bf16_f32 v30, v128, v129
v_cvt_pk_bf16_f32 v23, v122, v123
v_cvt_pk_bf16_f32 v31, v130, v131
v_and_b32 v13, 3, v1
v_lshl_or_b32 v13, v6, 3, v13
v_lshlrev_b32 v13, 6, v13
v_and_b32 v11, 16, v0
v_lshl_or_b32 v13, v11, 1, v13
v_and_b32 v11, 1, v0
v_lshl_or_b32 v13, v11, 4, v13
v_and_b32 v11, 2, v0
v_lshl_or_b32 v13, v11, 2, v13
s_lshl_b32 s18, s13, 11
s_add_u32 s18, s18, 0x18000
v_add_u32 v11, s18, v13
v_add_u32 v12, 0x18800, v13
s_xor_b32 s18, s10, s11
s_cmp_lg_u32 s12, 0
s_cselect_b32 s18, s11, s18
s_cmp_eq_u32 s18, 0
s_cselect_b32 s17, 0x80008000, 0
v_cmp_eq_u32 vcc, 0, v4
s_cmp_eq_u32 s4, 0
s_nop 2
s_cselect_b64 s[24:25], vcc, 0
s_mov_b32 s19, 0x80008000
v_xor_b32 v80, s17, v24
v_xor_b32 v88, s19, v24
v_xor_b32 v96, s17, v16
v_xor_b32 v81, s17, v25
v_xor_b32 v89, s19, v25
v_xor_b32 v97, s17, v17
v_xor_b32 v82, s17, v26
v_xor_b32 v90, s19, v26
v_xor_b32 v98, s17, v18
v_xor_b32 v83, s17, v27
v_xor_b32 v91, s19, v27
v_xor_b32 v99, s17, v19
v_xor_b32 v84, s17, v28
v_xor_b32 v92, s19, v28
v_xor_b32 v100, s17, v20
v_xor_b32 v85, s17, v29
v_xor_b32 v93, s19, v29
v_xor_b32 v101, s17, v21
v_xor_b32 v86, s17, v30
v_xor_b32 v94, s19, v30
v_xor_b32 v102, s17, v22
v_xor_b32 v87, s17, v31
v_xor_b32 v95, s19, v31
v_xor_b32 v103, s17, v23
s_lshl_b32 s18, s11, 5
s_add_u32 s18, s18, s5
s_lshl_b32 s18, s18, 10
s_lshl_b32 s19, s4, 7
s_add_u32 s18, s18, s19
s_lshl_b32 s19, s10, 6
s_add_u32 s18, s18, s19
s_add_u32 s29, s18, 0x800000
s_add_u32 s30, s29, 0x100000
s_lshl_b32 s19, s10, 12
s_lshl_b32 s20, s11, 11
s_add_u32 s19, s19, s20
s_add_u32 s19, s19, 0x18000
v_lshlrev_b32 v7, 4, v0
v_add_u32 v7, s19, v7
s_and_b32 s18, s5, 3
s_lshl_b32 s18, s18, 3
s_add_u32 s18, s18, s4
s_lshl_b32 s18, s18, 8
s_add_u32 s28, s18, 0x1020000
v_mov_b32 v60, 0
s_nop 0
FW6:
ds_read_b32 v255, v252 offset:336
s_waitcnt lgkmcnt(0)
v_cmp_eq_u32 vcc, 0, v255
s_nop 3
s_cbranch_vccz FW6_D
s_sleep 1
s_branch FW6
FW6_D:
s_mov_b32 s22, 0x2000
buffer_load_dwordx4 v[112:115], v8, s[76:79], s22 offen sc1
s_mov_b32 s22, 0xa000
buffer_load_dwordx4 v[116:119], v8, s[76:79], s22 offen sc1
s_mov_b32 s22, 0x3000
buffer_load_dwordx4 v[120:123], v8, s[76:79], s22 offen sc1
s_mov_b32 s22, 0xb000
buffer_load_dwordx4 v[124:127], v8, s[76:79], s22 offen sc1
s_mov_b32 s22, 0x4000
buffer_load_dwordx4 v[128:131], v8, s[76:79], s22 offen sc1
s_mov_b32 s22, 0xc000
buffer_load_dwordx4 v[132:135], v8, s[76:79], s22 offen sc1
s_mov_b32 s22, 0x5000
buffer_load_dwordx4 v[136:139], v8, s[76:79], s22 offen sc1
s_mov_b32 s22, 0xd000
buffer_load_dwordx4 v[140:143], v8, s[76:79], s22 offen sc1
s_mov_b32 s22, 0x6000
buffer_load_dwordx4 v[144:147], v8, s[76:79], s22 offen sc1
s_mov_b32 s22, 0xe000
buffer_load_dwordx4 v[148:151], v8, s[76:79], s22 offen sc1
s_mov_b32 s22, 0x7000
buffer_load_dwordx4 v[152:155], v8, s[76:79], s22 offen sc1
s_mov_b32 s22, 0xf000
buffer_load_dwordx4 v[156:159], v8, s[76:79], s22 offen sc1
s_mov_b64 exec, 1
buffer_load_dword v64, v60, s[76:79], s28 offen sc1
s_mov_b64 exec, -1
FW7:
ds_read_b32 v255, v252 offset:288
s_waitcnt lgkmcnt(0)
v_cmp_eq_u32 vcc, 0, v255
s_nop 3
s_cbranch_vccz FW7_D
s_branch FW7
FW7_D:
s_waitcnt vmcnt(12)
v_cvt_pk_bf16_f32 v112, v112, v113
v_cvt_pk_bf16_f32 v113, v114, v115
ds_write_b64 v10, v[112:113] offset:4352
s_waitcnt vmcnt(11)
v_cvt_pk_bf16_f32 v116, v116, v117
v_cvt_pk_bf16_f32 v117, v118, v119
ds_write_b64 v10, v[116:117] offset:21760
s_waitcnt vmcnt(10)
v_cvt_pk_bf16_f32 v120, v120, v121
v_cvt_pk_bf16_f32 v121, v122, v123
ds_write_b64 v10, v[120:121] offset:6528
s_waitcnt vmcnt(9)
v_cvt_pk_bf16_f32 v124, v124, v125
v_cvt_pk_bf16_f32 v125, v126, v127
ds_write_b64 v10, v[124:125] offset:23936
ds_write_b32 v253, v254 offset:160
s_waitcnt vmcnt(8)
v_cvt_pk_bf16_f32 v128, v128, v129
v_cvt_pk_bf16_f32 v129, v130, v131
ds_write_b64 v10, v[128:129] offset:8704
s_waitcnt vmcnt(7)
v_cvt_pk_bf16_f32 v132, v132, v133
v_cvt_pk_bf16_f32 v133, v134, v135
ds_write_b64 v10, v[132:133] offset:26112
s_waitcnt vmcnt(6)
v_cvt_pk_bf16_f32 v136, v136, v137
v_cvt_pk_bf16_f32 v137, v138, v139
ds_write_b64 v10, v[136:137] offset:10880
s_waitcnt vmcnt(5)
v_cvt_pk_bf16_f32 v140, v140, v141
v_cvt_pk_bf16_f32 v141, v142, v143
ds_write_b64 v10, v[140:141] offset:28288
ds_write_b32 v253, v254 offset:176
s_waitcnt vmcnt(4)
v_cvt_pk_bf16_f32 v144, v144, v145
v_cvt_pk_bf16_f32 v145, v146, v147
ds_write_b64 v10, v[144:145] offset:13056
s_waitcnt vmcnt(3)
v_cvt_pk_bf16_f32 v148, v148, v149
v_cvt_pk_bf16_f32 v149, v150, v151
ds_write_b64 v10, v[148:149] offset:30464
s_waitcnt vmcnt(2)
v_cvt_pk_bf16_f32 v152, v152, v153
v_cvt_pk_bf16_f32 v153, v154, v155
ds_write_b64 v10, v[152:153] offset:15232
s_waitcnt vmcnt(1)
v_cvt_pk_bf16_f32 v156, v156, v157
v_cvt_pk_bf16_f32 v157, v158, v159
ds_write_b64 v10, v[156:157] offset:32640
ds_write_b32 v253, v254 offset:192
s_waitcnt vmcnt(0)
v_readfirstlane_b32 s18, v64
s_nop 3
s_cmp_ge_u32 s18, 32
s_cselect_b32 s19, 1, 0
s_cmp_lg_u32 s3, 0
s_cbranch_scc1 HP_WAIT
s_cmp_lg_u32 s19, 0
s_cbranch_scc1 HP_DONE
s_mov_b32 s21, 0
s_mov_b64 exec, 1
HP_POLL:
buffer_load_dword v64, v60, s[76:79], s28 offen sc1
s_add_u32 s21, s21, 1
s_waitcnt vmcnt(0)
s_cmp_gt_u32 s21, 0x30d40
s_cbranch_scc1 HP_DONE
v_cmpx_gt_u32 vcc, 32, v64
s_nop 3
s_cbranch_execz HP_DONE
s_branch HP_POLL
HP_DONE:
s_mov_b64 exec, -1
ds_write_b32 v252, v254 offset:128
s_branch HP_GO
HP_WAIT:
s_cmp_lg_u32 s19, 0
s_cbranch_scc1 HP_GO
FW8:
ds_read_b32 v255, v252 offset:128
s_waitcnt lgkmcnt(0)
v_cmp_eq_u32 vcc, 0, v255
s_nop 3
s_cbranch_vccz FW8_D
s_sleep 1
s_branch FW8
FW8_D:
HP_GO:
buffer_load_dwordx4 v[104:107], v3, s[76:79], s29 offen sc1
buffer_load_dwordx4 v[108:111], v3, s[76:79], s30 offen sc1
s_waitcnt vmcnt(1)
ds_write_b128 v7, v[104:107]
s_waitcnt vmcnt(0)
ds_write_b128 v7, v[108:111] offset:1024
ds_write_b32 v253, v254 offset:208
FW9:
ds_read_b32 v255, v252 offset:208
s_waitcnt lgkmcnt(0)
v_cmp_eq_u32 vcc, 0, v255
s_nop 3
s_cbranch_vccz FW9_D
s_branch FW9
FW9_D:
ds_read_b64_tr_b16 v[32:33], v11 offset:0
ds_read_b64_tr_b16 v[34:35], v11 offset:256
ds_read_b64_tr_b16 v[36:37], v11 offset:1024
ds_read_b64_tr_b16 v[38:39], v11 offset:1280
ds_read_b64_tr_b16 v[40:41], v11 offset:4096
ds_read_b64_tr_b16 v[42:43], v11 offset:4352
ds_read_b64_tr_b16 v[44:45], v11 offset:5120
ds_read_b64_tr_b16 v[46:47], v11 offset:5376
ds_read_b64_tr_b16 v[48:49], v12 offset:0
ds_read_b64_tr_b16 v[50:51], v12 offset:256
ds_read_b64_tr_b16 v[52:53], v12 offset:1024
ds_read_b64_tr_b16 v[54:55], v12 offset:1280
ds_read_b64_tr_b16 v[56:57], v12 offset:4096
ds_read_b64_tr_b16 v[58:59], v12 offset:4352
ds_read_b64_tr_b16 v[60:61], v12 offset:5120
ds_read_b64_tr_b16 v[62:63], v12 offset:5376
s_waitcnt lgkmcnt(0)
s_cmp_eq_u32 s11, 0
s_cbranch_scc1 K2_FIXD
v_cndmask_b32 v32, v32, v40, s[24:25]
v_cndmask_b32 v48, v48, v56, s[24:25]
v_cndmask_b32 v33, v33, v41, s[24:25]
v_cndmask_b32 v49, v49, v57, s[24:25]
v_cndmask_b32 v34, v34, v42, s[24:25]
v_cndmask_b32 v50, v50, v58, s[24:25]
v_cndmask_b32 v35, v35, v43, s[24:25]
v_cndmask_b32 v51, v51, v59, s[24:25]
v_cndmask_b32 v36, v36, v44, s[24:25]
v_cndmask_b32 v52, v52, v60, s[24:25]
v_cndmask_b32 v37, v37, v45, s[24:25]
v_cndmask_b32 v53, v53, v61, s[24:25]
v_cndmask_b32 v38, v38, v46, s[24:25]
v_cndmask_b32 v54, v54, v62, s[24:25]
v_cndmask_b32 v39, v39, v47, s[24:25]
v_cndmask_b32 v55, v55, v63, s[24:25]
s_nop 0
K2_FIXD:
v_cndmask_b32 v40, v40, 0, s[24:25]
v_cndmask_b32 v56, v56, 0, s[24:25]
v_cndmask_b32 v41, v41, 0, s[24:25]
v_cndmask_b32 v57, v57, 0, s[24:25]
v_cndmask_b32 v42, v42, 0, s[24:25]
v_cndmask_b32 v58, v58, 0, s[24:25]
v_cndmask_b32 v43, v43, 0, s[24:25]
v_cndmask_b32 v59, v59, 0, s[24:25]
v_cndmask_b32 v44, v44, 0, s[24:25]
v_cndmask_b32 v60, v60, 0, s[24:25]
v_cndmask_b32 v45, v45, 0, s[24:25]
v_cndmask_b32 v61, v61, 0, s[24:25]
v_cndmask_b32 v46, v46, 0, s[24:25]
v_cndmask_b32 v62, v62, 0, s[24:25]
v_cndmask_b32 v47, v47, 0, s[24:25]
v_cndmask_b32 v63, v63, 0, s[24:25]
v_mfma_f32_32x32x16_bf16 v[64:79], v[32:35], v[16:19], 0
v_mfma_f32_32x32x16_bf16 v[64:79], v[36:39], v[20:23], v[64:79]
v_mfma_f32_32x32x16_bf16 v[64:79], v[40:43], v[80:83], v[64:79]
v_mfma_f32_32x32x16_bf16 v[64:79], v[44:47], v[84:87], v[64:79]
s_cmp_lg_u32 s12, 0
s_nop 9
s_cbranch_scc1 K2_B0DONE
v_mfma_f32_32x32x16_bf16 v[64:79], v[48:51], v[88:91], v[64:79]
v_mfma_f32_32x32x16_bf16 v[64:79], v[52:55], v[92:95], v[64:79]
v_mfma_f32_32x32x16_bf16 v[64:79], v[56:59], v[96:99], v[64:79]
v_mfma_f32_32x32x16_bf16 v[64:79], v[60:63], v[100:103], v[64:79]
s_nop 10
K2_B0DONE:
s_andn2_b32 s18, s10, s12
v_sub_u32 v13, 0x800, v5
s_cmp_lg_u32 s18, 0
s_cselect_b64 vcc, -1, 0
v_cndmask_b32 v13, v5, v13, vcc
v_lshlrev_b32 v13, 11, v13
s_cmp_lg_u32 s11, 0
s_cbranch_scc1 K2_BMIR
v_cvt_pk_bf16_f32 v104, v64, v65
v_cvt_pk_bf16_f32 v105, v66, v67
v_cvt_pk_bf16_f32 v106, v68, v69
v_cvt_pk_bf16_f32 v107, v70, v71
v_cvt_pk_bf16_f32 v108, v72, v73
v_cvt_pk_bf16_f32 v109, v74, v75
v_cvt_pk_bf16_f32 v110, v76, v77
v_cvt_pk_bf16_f32 v111, v78, v79
v_lshl_add_u32 v13, v6, 4, v13
s_lshl_b32 s18, s4, 6
s_add_u32 s18, s18, 1024
buffer_store_dwordx4 v[104:107], v13, s[96:99], s18 offen nt
buffer_store_dwordx4 v[108:111], v13, s[96:99], s18 offen offset:32 nt
s_branch K2_BDONE
K2_BMIR:
v_cvt_pk_bf16_f32 v104, v70, v69
v_cvt_pk_bf16_f32 v105, v68, v67
v_cvt_pk_bf16_f32 v106, v66, v65
v_cvt_pk_bf16_f32 v107, v71, v64
v_cvt_pk_bf16_f32 v108, v78, v77
v_cvt_pk_bf16_f32 v109, v76, v75
v_cvt_pk_bf16_f32 v110, v74, v73
v_cvt_pk_bf16_f32 v111, v79, v72
v_xor_b32 v14, 1, v6
v_lshl_add_u32 v14, v14, 4, v13
s_lshl_b32 s18, s4, 6
s_sub_u32 s18, 1986, s18
buffer_store_short v107, v14, s[96:99], s18 offen offset:32 nt
buffer_store_dwordx3 v[104:106], v14, s[96:99], s18 offen offset:34 nt
buffer_store_short v111, v14, s[96:99], s18 offen offset:0 nt
buffer_store_dwordx3 v[108:110], v14, s[96:99], s18 offen offset:2 nt
buffer_store_short_d16_hi v111, v14, s[96:99], s18 offen offset:14 nt
v_add_u32 v15, s18, v14
v_add_u32 v15, 46, v15
v_add_u32 v14, 0x600, v13
v_cmp_gt_u32 vcc, 32, v0
s_cmp_eq_u32 s4, 0
s_nop 2
s_cselect_b64 vcc, vcc, 0
v_cndmask_b32 v15, v15, v14, vcc
buffer_store_short_d16_hi v107, v15, s[96:99], 0 offen nt
K2_BDONE:
s_endpgm
K1_COMPUTE:
s_mov_b32 s78, 0x4000000
s_mov_b32 s79, 0x00020000
s_mov_b32 s90, 0x4000
s_mov_b32 s91, 0x00020000
v_mov_b32 v38, 0
s_or_b32 s14, s8, s3
s_lshl_b32 s15, s9, 3
s_and_b32 s18, s3, 1
s_lshl_b32 s18, s18, 2
v_lshrrev_b32 v224, 4, v0
v_add_u32 v225, s18, v224
v_and_b32 v226, 7, v0
v_xor_b32 v225, v225, v226
v_lshlrev_b32 v225, 4, v225
v_lshrrev_b32 v226, 3, v0
v_lshl_or_b32 v222, v226, 10, v225
v_lshrrev_b32 v225, 2, v0
v_mul_u32_u24 v225, 0xc00, v225
v_and_b32 v226, 3, v0
v_lshl_or_b32 v223, v226, 4, v225
s_lshl_b32 s68, s8, 17
s_lshl_b32 s18, s3, 13
s_add_u32 s68, s68, s18
s_mul_i32 s69, s3, 0xc000
s_lshl_b32 s18, s9, 6
s_add_u32 s69, s69, s18
s_lshl_b32 s70, s3, 10
s_mov_b32 s58, 0x200000
s_mov_b32 s59, 0x00020000
s_mov_b32 s62, 0x180000
s_mov_b32 s63, 0x00020000
s_waitcnt lgkmcnt(0)
s_mov_b32 s56, s32
s_mov_b32 s57, s33
s_mov_b32 s60, s34
s_mov_b32 s61, s35
s_add_u32 s22, s87, 0
s_and_b32 s22, s22, 7
s_lshl_b32 s23, s22, 7
s_add_u32 s23, s23, s68
s_mul_i32 s24, s22, 0x30000
s_add_u32 s24, s24, s69
s_add_u32 m0, s70, 0x0
s_add_u32 s18, s23, 0x0
buffer_load_dwordx4 v222, s[56:59], s18 offen lds
s_add_u32 m0, s70, 0x1000
s_add_u32 s18, s23, 0x8000
buffer_load_dwordx4 v222, s[56:59], s18 offen lds
s_add_u32 m0, s70, 0x2000
s_add_u32 s18, s23, 0x10000
buffer_load_dwordx4 v222, s[56:59], s18 offen lds
s_add_u32 m0, s70, 0x3000
s_add_u32 s18, s23, 0x18000
buffer_load_dwordx4 v222, s[56:59], s18 offen lds
s_add_u32 m0, s70, 0x4000
s_add_u32 s18, s24, 0x0
buffer_load_dwordx4 v223, s[60:63], s18 offen lds
s_add_u32 m0, s70, 0x5000
s_add_u32 s18, s24, 0x400
buffer_load_dwordx4 v223, s[60:63], s18 offen lds
s_add_u32 m0, s70, 0x6000
s_add_u32 s18, s24, 0x800
buffer_load_dwordx4 v223, s[60:63], s18 offen lds
s_add_u32 s22, s87, 1
s_and_b32 s22, s22, 7
s_lshl_b32 s23, s22, 7
s_add_u32 s23, s23, s68
s_mul_i32 s24, s22, 0x30000
s_add_u32 s24, s24, s69
s_add_u32 m0, s70, 0x8000
s_add_u32 s18, s23, 0x0
buffer_load_dwordx4 v222, s[56:59], s18 offen lds
s_add_u32 m0, s70, 0x9000
s_add_u32 s18, s23, 0x8000
buffer_load_dwordx4 v222, s[56:59], s18 offen lds
s_add_u32 m0, s70, 0xa000
s_add_u32 s18, s23, 0x10000
buffer_load_dwordx4 v222, s[56:59], s18 offen lds
s_add_u32 m0, s70, 0xb000
s_add_u32 s18, s23, 0x18000
buffer_load_dwordx4 v222, s[56:59], s18 offen lds
s_add_u32 m0, s70, 0xc000
s_add_u32 s18, s24, 0x0
buffer_load_dwordx4 v223, s[60:63], s18 offen lds
s_add_u32 m0, s70, 0xd000
s_add_u32 s18, s24, 0x400
buffer_load_dwordx4 v223, s[60:63], s18 offen lds
s_add_u32 m0, s70, 0xe000
s_add_u32 s18, s24, 0x800
buffer_load_dwordx4 v223, s[60:63], s18 offen lds
s_add_u32 s22, s87, 2
s_and_b32 s22, s22, 7
s_lshl_b32 s23, s22, 7
s_add_u32 s23, s23, s68
s_mul_i32 s24, s22, 0x30000
s_add_u32 s24, s24, s69
s_add_u32 m0, s70, 0x10000
s_add_u32 s18, s23, 0x0
buffer_load_dwordx4 v222, s[56:59], s18 offen lds
s_add_u32 m0, s70, 0x11000
s_add_u32 s18, s23, 0x8000
buffer_load_dwordx4 v222, s[56:59], s18 offen lds
s_add_u32 m0, s70, 0x12000
s_add_u32 s18, s23, 0x10000
buffer_load_dwordx4 v222, s[56:59], s18 offen lds
s_add_u32 m0, s70, 0x13000
s_add_u32 s18, s23, 0x18000
buffer_load_dwordx4 v222, s[56:59], s18 offen lds
s_add_u32 m0, s70, 0x14000
s_add_u32 s18, s24, 0x0
buffer_load_dwordx4 v223, s[60:63], s18 offen lds
s_add_u32 m0, s70, 0x15000
s_add_u32 s18, s24, 0x400
buffer_load_dwordx4 v223, s[60:63], s18 offen lds
s_add_u32 m0, s70, 0x16000
s_add_u32 s18, s24, 0x800
buffer_load_dwordx4 v223, s[60:63], s18 offen lds
s_add_u32 s22, s87, 3
s_and_b32 s22, s22, 7
s_lshl_b32 s23, s22, 7
s_add_u32 s23, s23, s68
s_mul_i32 s24, s22, 0x30000
s_add_u32 s24, s24, s69
s_add_u32 m0, s70, 0x18000
s_add_u32 s18, s23, 0x0
buffer_load_dwordx4 v222, s[56:59], s18 offen lds
s_add_u32 m0, s70, 0x19000
s_add_u32 s18, s23, 0x8000
buffer_load_dwordx4 v222, s[56:59], s18 offen lds
s_add_u32 m0, s70, 0x1a000
s_add_u32 s18, s23, 0x10000
buffer_load_dwordx4 v222, s[56:59], s18 offen lds
s_add_u32 m0, s70, 0x1b000
s_add_u32 s18, s23, 0x18000
buffer_load_dwordx4 v222, s[56:59], s18 offen lds
s_add_u32 m0, s70, 0x1c000
s_add_u32 s18, s24, 0x0
buffer_load_dwordx4 v223, s[60:63], s18 offen lds
s_add_u32 m0, s70, 0x1d000
s_add_u32 s18, s24, 0x400
buffer_load_dwordx4 v223, s[60:63], s18 offen lds
s_add_u32 m0, s70, 0x1e000
s_add_u32 s18, s24, 0x800
buffer_load_dwordx4 v223, s[60:63], s18 offen lds
s_mov_b32 s64, s40
s_mov_b32 s65, s41
s_mov_b32 s66, 0x200000
s_mov_b32 s67, 0x00020000
v_lshrrev_b32 v225, 4, v0
s_lshl_b32 s18, s3, 2
v_add_u32 v226, s18, v225
v_and_b32 v224, 15, v0
v_xor_b32 v226, v226, v224
v_lshlrev_b32 v226, 4, v226
v_lshl_or_b32 v224, v225, 15, v226
s_lshl_b32 s71, s3, 7
s_add_u32 s71, s71, s10
s_lshl_b32 s71, s71, 10
s_mov_b32 s76, s54
s_mov_b32 s77, s55
s_mov_b32 s88, s36
s_mov_b32 s89, s37
s_add_u32 s16, s52, s15
s_addc_u32 s17, s53, 0
v_and_b32 v172, 31, v0
v_lshrrev_b32 v173, 5, v0
v_lshrrev_b32 v174, 2, v0
v_and_b32 v174, 3, v174
v_lshl_or_b32 v173, v173, 3, v174
v_lshlrev_b32 v173, 5, v173
v_and_b32 v174, 16, v0
v_lshl_or_b32 v173, v174, 5, v173
v_and_b32 v174, 1, v0
v_lshl_or_b32 v173, v174, 4, v173
v_and_b32 v174, 2, v0
v_lshl_or_b32 v173, v174, 2, v173
v_add_u32 v170, 0x17000, v173
v_mov_b32 v36, v172
v_lshrrev_b32 v176, 5, v0
s_lshl_b32 s18, s3, 5
v_add_u32 v177, s18, v36
v_lshrrev_b32 v178, 1, v177
v_and_b32 v178, 7, v178
v_xor_b32 v178, v178, v176
v_lshlrev_b32 v178, 4, v178
v_lshl_or_b32 v2, v177, 7, v178
v_xor_b32 v3, 0x20, v2
v_xor_b32 v4, 0x40, v2
v_xor_b32 v5, 0x60, v2
v_add_u32 v6, 0x10000, v2
v_add_u32 v7, 0x10000, v3
v_add_u32 v8, 0x10000, v4
v_add_u32 v9, 0x10000, v5
v_add_u32 v10, 0x20000, v2
v_add_u32 v11, 0x20000, v3
v_add_u32 v12, 0x20000, v4
v_add_u32 v13, 0x20000, v5
v_lshrrev_b32 v177, 2, v0
v_and_b32 v177, 3, v177
v_lshl_or_b32 v177, v176, 3, v177
v_lshlrev_b32 v177, 6, v177
v_and_b32 v178, 16, v0
v_lshl_or_b32 v177, v178, 1, v177
v_and_b32 v178, 3, v0
v_lshl_or_b32 v17, v178, 3, v177
v_and_b32 v178, 1, v0
v_lshl_or_b32 v14, v178, 4, v177
v_and_b32 v178, 2, v0
v_lshl_or_b32 v14, v178, 2, v14
v_add_u32 v15, 0x10000, v14
v_add_u32 v18, 0x10000, v17
v_add_u32 v16, 0x20000, v14
v_add_u32 v19, 0x20000, v17
v_lshlrev_b32 v177, 3, v176
v_sub_u32 v177, v36, v177
v_and_b32 v178, 1, v177
v_lshlrev_b32 v178, 4, v178
v_mov_b32 v176, 0x3f80
v_lshlrev_b32 v178, v178, v176
v_ashrrev_i32 v176, 1, v177
v_cmp_eq_u32 vcc, 0, v176
s_nop 1
v_cndmask_b32 v28, 0, v178, vcc
v_cmp_eq_u32 vcc, 1, v176
s_nop 1
v_cndmask_b32 v29, 0, v178, vcc
v_cmp_eq_u32 vcc, 2, v176
s_nop 1
v_cndmask_b32 v30, 0, v178, vcc
v_cmp_eq_u32 vcc, 3, v176
s_nop 1
v_cndmask_b32 v31, 0, v178, vcc
v_subrev_u32 v177, 16, v177
v_and_b32 v178, 1, v177
v_lshlrev_b32 v178, 4, v178
v_mov_b32 v176, 0x3f80
v_lshlrev_b32 v178, v178, v176
v_ashrrev_i32 v176, 1, v177
v_cmp_eq_u32 vcc, 0, v176
s_nop 1
v_cndmask_b32 v32, 0, v178, vcc
v_cmp_eq_u32 vcc, 1, v176
s_nop 1
v_cndmask_b32 v33, 0, v178, vcc
v_cmp_eq_u32 vcc, 2, v176
s_nop 1
v_cndmask_b32 v34, 0, v178, vcc
v_cmp_eq_u32 vcc, 3, v176
s_nop 1
v_cndmask_b32 v35, 0, v178, vcc
v_mov_b32 v56, 0
v_mov_b32 v57, 0
v_mov_b32 v58, 0
v_mov_b32 v59, 0
v_mov_b32 v60, 0
v_mov_b32 v61, 0
v_mov_b32 v62, 0
v_mov_b32 v63, 0
v_mov_b32 v64, 0
v_mov_b32 v65, 0
v_mov_b32 v66, 0
v_mov_b32 v67, 0
v_mov_b32 v68, 0
v_mov_b32 v69, 0
v_mov_b32 v70, 0
v_mov_b32 v71, 0
v_mov_b32 v72, 0
v_mov_b32 v73, 0
v_mov_b32 v74, 0
v_mov_b32 v75, 0
v_mov_b32 v76, 0
v_mov_b32 v77, 0
v_mov_b32 v78, 0
v_mov_b32 v79, 0
v_mov_b32 v80, 0
v_mov_b32 v81, 0
v_mov_b32 v82, 0
v_mov_b32 v83, 0
v_mov_b32 v84, 0
v_mov_b32 v85, 0
v_mov_b32 v86, 0
v_mov_b32 v87, 0
v_and_b32 v221, 7, v0
v_lshlrev_b32 v221, 2, v221
v_add_u32 v221, 0x17400, v221
v_lshlrev_b32 v152, 4, v0
v_and_b32 v216, 3, v0
v_lshlrev_b32 v216, 2, v216
v_add_u32 v216, 0x17400, v216
s_lshl_b32 s18, s3, 2
s_add_u32 s18, s18, 0x17400
v_mov_b32 v217, s18
v_mov_b32 v218, 1
s_waitcnt vmcnt(21)
s_barrier
ds_read_b128 v[88:91], v2 offset:0
ds_read_b64_tr_b16 v[96:97], v14 offset:20480
ds_read_b64_tr_b16 v[98:99], v14 offset:20736
ds_read_b64_tr_b16 v[100:101], v17 offset:24576
ds_read_b64_tr_b16 v[102:103], v17 offset:24832
ds_read_b128 v[104:107], v3 offset:0
ds_read_b64_tr_b16 v[112:113], v14 offset:21504
ds_read_b64_tr_b16 v[114:115], v14 offset:21760
ds_read_b64_tr_b16 v[116:117], v17 offset:25600
ds_read_b64_tr_b16 v[118:119], v17 offset:25856
ds_read_b128 v[120:123], v4 offset:0
ds_read_b64_tr_b16 v[128:129], v14 offset:22528
ds_read_b64_tr_b16 v[130:131], v14 offset:22784
ds_read_b64_tr_b16 v[132:133], v17 offset:26624
ds_read_b64_tr_b16 v[134:135], v17 offset:26880
s_waitcnt lgkmcnt(10)
v_mfma_f32_32x32x16_bf16 v[56:71], v[96:99], v[88:91], v[56:71]
v_mfma_f32_32x32x16_bf16 v[72:87], v[88:91], v[100:103], v[72:87]
ds_read_b128 v[136:139], v5 offset:0
ds_read_b64_tr_b16 v[144:145], v14 offset:23552
ds_read_b64_tr_b16 v[146:147], v14 offset:23808
ds_read_b64_tr_b16 v[148:149], v17 offset:27648
ds_read_b64_tr_b16 v[150:151], v17 offset:27904
s_waitcnt lgkmcnt(10)
v_mfma_f32_32x32x16_bf16 v[56:71], v[112:115], v[104:107], v[56:71]
v_mfma_f32_32x32x16_bf16 v[72:87], v[104:107], v[116:119], v[72:87]
s_waitcnt vmcnt(14) lgkmcnt(0)
s_barrier
ds_read_b128 v[88:91], v2 offset:32768
ds_read_b64_tr_b16 v[96:97], v14 offset:53248
ds_read_b64_tr_b16 v[98:99], v14 offset:53504
ds_read_b64_tr_b16 v[100:101], v17 offset:57344
ds_read_b64_tr_b16 v[102:103], v17 offset:57600
s_waitcnt lgkmcnt(10)
v_mfma_f32_32x32x16_bf16 v[56:71], v[128:131], v[120:123], v[56:71]
v_mfma_f32_32x32x16_bf16 v[72:87], v[120:123], v[132:135], v[72:87]
ds_read_b128 v[104:107], v3 offset:32768
ds_read_b64_tr_b16 v[112:113], v14 offset:54272
ds_read_b64_tr_b16 v[114:115], v14 offset:54528
ds_read_b64_tr_b16 v[116:117], v17 offset:58368
ds_read_b64_tr_b16 v[118:119], v17 offset:58624
s_waitcnt lgkmcnt(10)
v_mfma_f32_32x32x16_bf16 v[56:71], v[144:147], v[136:139], v[56:71]
v_mfma_f32_32x32x16_bf16 v[72:87], v[136:139], v[148:151], v[72:87]
ds_read_b128 v[120:123], v4 offset:32768
ds_read_b64_tr_b16 v[128:129], v14 offset:55296
ds_read_b64_tr_b16 v[130:131], v14 offset:55552
ds_read_b64_tr_b16 v[132:133], v17 offset:59392
ds_read_b64_tr_b16 v[134:135], v17 offset:59648
s_waitcnt lgkmcnt(10)
v_mfma_f32_32x32x16_bf16 v[56:71], v[96:99], v[88:91], v[56:71]
v_mfma_f32_32x32x16_bf16 v[72:87], v[88:91], v[100:103], v[72:87]
ds_read_b128 v[136:139], v5 offset:32768
ds_read_b64_tr_b16 v[144:145], v14 offset:56320
ds_read_b64_tr_b16 v[146:147], v14 offset:56576
ds_read_b64_tr_b16 v[148:149], v17 offset:60416
ds_read_b64_tr_b16 v[150:151], v17 offset:60672
s_waitcnt lgkmcnt(10)
v_mfma_f32_32x32x16_bf16 v[56:71], v[112:115], v[104:107], v[56:71]
v_mfma_f32_32x32x16_bf16 v[72:87], v[104:107], v[116:119], v[72:87]
s_waitcnt vmcnt(7) lgkmcnt(0)
s_barrier
ds_read_b128 v[88:91], v6 offset:0
ds_read_b64_tr_b16 v[96:97], v15 offset:20480
ds_read_b64_tr_b16 v[98:99], v15 offset:20736
ds_read_b64_tr_b16 v[100:101], v18 offset:24576
ds_read_b64_tr_b16 v[102:103], v18 offset:24832
s_waitcnt lgkmcnt(10)
v_mfma_f32_32x32x16_bf16 v[56:71], v[128:131], v[120:123], v[56:71]
v_mfma_f32_32x32x16_bf16 v[72:87], v[120:123], v[132:135], v[72:87]
ds_read_b128 v[104:107], v7 offset:0
ds_read_b64_tr_b16 v[112:113], v15 offset:21504
ds_read_b64_tr_b16 v[114:115], v15 offset:21760
ds_read_b64_tr_b16 v[116:117], v18 offset:25600
ds_read_b64_tr_b16 v[118:119], v18 offset:25856
s_waitcnt lgkmcnt(10)
v_mfma_f32_32x32x16_bf16 v[56:71], v[144:147], v[136:139], v[56:71]
v_mfma_f32_32x32x16_bf16 v[72:87], v[136:139], v[148:151], v[72:87]
ds_read_b128 v[120:123], v8 offset:0
ds_read_b64_tr_b16 v[128:129], v15 offset:22528
ds_read_b64_tr_b16 v[130:131], v15 offset:22784
ds_read_b64_tr_b16 v[132:133], v18 offset:26624
ds_read_b64_tr_b16 v[134:135], v18 offset:26880
s_waitcnt lgkmcnt(10)
v_mfma_f32_32x32x16_bf16 v[56:71], v[96:99], v[88:91], v[56:71]
v_mfma_f32_32x32x16_bf16 v[72:87], v[88:91], v[100:103], v[72:87]
ds_read_b128 v[136:139], v9 offset:0
ds_read_b64_tr_b16 v[144:145], v15 offset:23552
ds_read_b64_tr_b16 v[146:147], v15 offset:23808
ds_read_b64_tr_b16 v[148:149], v18 offset:27648
ds_read_b64_tr_b16 v[150:151], v18 offset:27904
s_waitcnt lgkmcnt(10)
v_mfma_f32_32x32x16_bf16 v[56:71], v[112:115], v[104:107], v[56:71]
v_mfma_f32_32x32x16_bf16 v[72:87], v[104:107], v[116:119], v[72:87]
s_waitcnt vmcnt(0) lgkmcnt(0)
s_barrier
ds_read_b128 v[88:91], v6 offset:32768
ds_read_b64_tr_b16 v[96:97], v15 offset:53248
ds_read_b64_tr_b16 v[98:99], v15 offset:53504
ds_read_b64_tr_b16 v[100:101], v18 offset:57344
ds_read_b64_tr_b16 v[102:103], v18 offset:57600
s_waitcnt lgkmcnt(10)
v_mfma_f32_32x32x16_bf16 v[56:71], v[128:131], v[120:123], v[56:71]
v_mfma_f32_32x32x16_bf16 v[72:87], v[120:123], v[132:135], v[72:87]
ds_read_b128 v[104:107], v7 offset:32768
ds_read_b64_tr_b16 v[112:113], v15 offset:54272
ds_read_b64_tr_b16 v[114:115], v15 offset:54528
ds_read_b64_tr_b16 v[116:117], v18 offset:58368
ds_read_b64_tr_b16 v[118:119], v18 offset:58624
s_waitcnt lgkmcnt(10)
v_mfma_f32_32x32x16_bf16 v[56:71], v[144:147], v[136:139], v[56:71]
v_mfma_f32_32x32x16_bf16 v[72:87], v[136:139], v[148:151], v[72:87]
ds_read_b128 v[120:123], v8 offset:32768
ds_read_b64_tr_b16 v[128:129], v15 offset:55296
ds_read_b64_tr_b16 v[130:131], v15 offset:55552
ds_read_b64_tr_b16 v[132:133], v18 offset:59392
ds_read_b64_tr_b16 v[134:135], v18 offset:59648
s_waitcnt lgkmcnt(10)
v_mfma_f32_32x32x16_bf16 v[56:71], v[96:99], v[88:91], v[56:71]
v_mfma_f32_32x32x16_bf16 v[72:87], v[88:91], v[100:103], v[72:87]
ds_read_b128 v[136:139], v9 offset:32768
ds_read_b64_tr_b16 v[144:145], v15 offset:56320
ds_read_b64_tr_b16 v[146:147], v15 offset:56576
ds_read_b64_tr_b16 v[148:149], v18 offset:60416
ds_read_b64_tr_b16 v[150:151], v18 offset:60672
s_waitcnt lgkmcnt(10)
v_mfma_f32_32x32x16_bf16 v[56:71], v[112:115], v[104:107], v[56:71]
v_mfma_f32_32x32x16_bf16 v[72:87], v[104:107], v[116:119], v[72:87]
s_waitcnt lgkmcnt(0)
s_barrier
ds_read_b128 v[88:91], v10 offset:0
ds_read_b64_tr_b16 v[96:97], v16 offset:20480
ds_read_b64_tr_b16 v[98:99], v16 offset:20736
ds_read_b64_tr_b16 v[100:101], v19 offset:24576
ds_read_b64_tr_b16 v[102:103], v19 offset:24832
s_waitcnt lgkmcnt(10)
v_mfma_f32_32x32x16_bf16 v[56:71], v[128:131], v[120:123], v[56:71]
s_add_u32 s22, s86, 0
s_and_b32 s22, s22, 3
s_lshl_b32 s22, s22, 8
s_add_u32 s23, s71, s22
s_add_u32 m0, s70, 0x18000
s_add_u32 s18, s23, 0x0
buffer_load_dwordx4 v224, s[64:67], s18 offen lds
v_mfma_f32_32x32x16_bf16 v[72:87], v[120:123], v[132:135], v[72:87]
s_add_u32 m0, s70, 0x19000
s_add_u32 s18, s23, 0x80000
buffer_load_dwordx4 v224, s[64:67], s18 offen lds
ds_read_b128 v[104:107], v11 offset:0
ds_read_b64_tr_b16 v[112:113], v16 offset:21504
ds_read_b64_tr_b16 v[114:115], v16 offset:21760
ds_read_b64_tr_b16 v[116:117], v19 offset:25600
ds_read_b64_tr_b16 v[118:119], v19 offset:25856
s_waitcnt lgkmcnt(10)
v_mfma_f32_32x32x16_bf16 v[56:71], v[144:147], v[136:139], v[56:71]
s_add_u32 m0, s70, 0x1a000
s_add_u32 s18, s23, 0x100000
buffer_load_dwordx4 v224, s[64:67], s18 offen lds
v_mfma_f32_32x32x16_bf16 v[72:87], v[136:139], v[148:151], v[72:87]
s_add_u32 m0, s70, 0x1b000
s_add_u32 s18, s23, 0x180000
buffer_load_dwordx4 v224, s[64:67], s18 offen lds
ds_read_b128 v[120:123], v12 offset:0
ds_read_b64_tr_b16 v[128:129], v16 offset:22528
ds_read_b64_tr_b16 v[130:131], v16 offset:22784
ds_read_b64_tr_b16 v[132:133], v19 offset:26624
ds_read_b64_tr_b16 v[134:135], v19 offset:26880
s_waitcnt lgkmcnt(10)
v_mfma_f32_32x32x16_bf16 v[56:71], v[96:99], v[88:91], v[56:71]
s_add_u32 s22, s86, 1
s_and_b32 s22, s22, 3
s_lshl_b32 s22, s22, 8
s_add_u32 s23, s71, s22
s_add_u32 m0, s70, 0x1c000
s_add_u32 s18, s23, 0x0
buffer_load_dwordx4 v224, s[64:67], s18 offen lds
v_mfma_f32_32x32x16_bf16 v[72:87], v[88:91], v[100:103], v[72:87]
s_add_u32 m0, s70, 0x1d000
s_add_u32 s18, s23, 0x80000
buffer_load_dwordx4 v224, s[64:67], s18 offen lds
ds_read_b128 v[136:139], v13 offset:0
ds_read_b64_tr_b16 v[144:145], v16 offset:23552
ds_read_b64_tr_b16 v[146:147], v16 offset:23808
ds_read_b64_tr_b16 v[148:149], v19 offset:27648
ds_read_b64_tr_b16 v[150:151], v19 offset:27904
s_waitcnt lgkmcnt(10)
v_mfma_f32_32x32x16_bf16 v[56:71], v[112:115], v[104:107], v[56:71]
s_add_u32 m0, s70, 0x1e000
s_add_u32 s18, s23, 0x100000
buffer_load_dwordx4 v224, s[64:67], s18 offen lds
v_mfma_f32_32x32x16_bf16 v[72:87], v[104:107], v[116:119], v[72:87]
s_add_u32 m0, s70, 0x1f000
s_add_u32 s18, s23, 0x180000
buffer_load_dwordx4 v224, s[64:67], s18 offen lds
s_waitcnt lgkmcnt(0)
s_barrier
ds_read_b128 v[88:91], v2 offset:0
ds_read_b64_tr_b16 v[96:97], v14 offset:20480
ds_read_b64_tr_b16 v[98:99], v14 offset:20736
ds_read_b64_tr_b16 v[100:101], v17 offset:24576
ds_read_b64_tr_b16 v[102:103], v17 offset:24832
s_waitcnt lgkmcnt(10)
v_mfma_f32_32x32x16_bf16 v[56:71], v[128:131], v[120:123], v[56:71]
s_add_u32 s22, s86, 2
s_and_b32 s22, s22, 3
s_lshl_b32 s22, s22, 8
s_add_u32 s23, s71, s22
s_add_u32 m0, s70, 0x20000
s_add_u32 s18, s23, 0x0
buffer_load_dwordx4 v224, s[64:67], s18 offen lds
v_mfma_f32_32x32x16_bf16 v[72:87], v[120:123], v[132:135], v[72:87]
s_add_u32 m0, s70, 0x21000
s_add_u32 s18, s23, 0x80000
buffer_load_dwordx4 v224, s[64:67], s18 offen lds
ds_read_b128 v[104:107], v3 offset:0
ds_read_b64_tr_b16 v[112:113], v14 offset:21504
ds_read_b64_tr_b16 v[114:115], v14 offset:21760
ds_read_b64_tr_b16 v[116:117], v17 offset:25600
ds_read_b64_tr_b16 v[118:119], v17 offset:25856
s_waitcnt lgkmcnt(10)
v_mfma_f32_32x32x16_bf16 v[56:71], v[144:147], v[136:139], v[56:71]
s_add_u32 m0, s70, 0x22000
s_add_u32 s18, s23, 0x100000
buffer_load_dwordx4 v224, s[64:67], s18 offen lds
v_mfma_f32_32x32x16_bf16 v[72:87], v[136:139], v[148:151], v[72:87]
s_add_u32 m0, s70, 0x23000
s_add_u32 s18, s23, 0x180000
buffer_load_dwordx4 v224, s[64:67], s18 offen lds
ds_read_b128 v[120:123], v4 offset:0
ds_read_b64_tr_b16 v[128:129], v14 offset:22528
ds_read_b64_tr_b16 v[130:131], v14 offset:22784
ds_read_b64_tr_b16 v[132:133], v17 offset:26624
ds_read_b64_tr_b16 v[134:135], v17 offset:26880
s_waitcnt lgkmcnt(10)
v_mfma_f32_32x32x16_bf16 v[56:71], v[96:99], v[88:91], v[56:71]
s_add_u32 s22, s86, 3
s_and_b32 s22, s22, 3
s_lshl_b32 s22, s22, 8
s_add_u32 s23, s71, s22
s_add_u32 m0, s70, 0x24000
s_add_u32 s18, s23, 0x0
buffer_load_dwordx4 v224, s[64:67], s18 offen lds
v_mfma_f32_32x32x16_bf16 v[72:87], v[88:91], v[100:103], v[72:87]
s_add_u32 m0, s70, 0x25000
s_add_u32 s18, s23, 0x80000
buffer_load_dwordx4 v224, s[64:67], s18 offen lds
ds_read_b128 v[136:139], v5 offset:0
ds_read_b64_tr_b16 v[144:145], v14 offset:23552
ds_read_b64_tr_b16 v[146:147], v14 offset:23808
ds_read_b64_tr_b16 v[148:149], v17 offset:27648
ds_read_b64_tr_b16 v[150:151], v17 offset:27904
s_waitcnt lgkmcnt(10)
v_mfma_f32_32x32x16_bf16 v[56:71], v[112:115], v[104:107], v[56:71]
s_add_u32 m0, s70, 0x26000
s_add_u32 s18, s23, 0x100000
buffer_load_dwordx4 v224, s[64:67], s18 offen lds
v_mfma_f32_32x32x16_bf16 v[72:87], v[104:107], v[116:119], v[72:87]
s_add_u32 m0, s70, 0x27000
s_add_u32 s18, s23, 0x180000
buffer_load_dwordx4 v224, s[64:67], s18 offen lds
s_waitcnt lgkmcnt(0)
s_barrier
ds_read_b128 v[88:91], v2 offset:32768
ds_read_b64_tr_b16 v[96:97], v14 offset:53248
ds_read_b64_tr_b16 v[98:99], v14 offset:53504
ds_read_b64_tr_b16 v[100:101], v17 offset:57344
ds_read_b64_tr_b16 v[102:103], v17 offset:57600
s_waitcnt lgkmcnt(10)
v_mfma_f32_32x32x16_bf16 v[56:71], v[128:131], v[120:123], v[56:71]
v_mfma_f32_32x32x16_bf16 v[72:87], v[120:123], v[132:135], v[72:87]
ds_read_b128 v[104:107], v3 offset:32768
ds_read_b64_tr_b16 v[112:113], v14 offset:54272
ds_read_b64_tr_b16 v[114:115], v14 offset:54528
ds_read_b64_tr_b16 v[116:117], v17 offset:58368
ds_read_b64_tr_b16 v[118:119], v17 offset:58624
s_waitcnt lgkmcnt(10)
v_mfma_f32_32x32x16_bf16 v[56:71], v[144:147], v[136:139], v[56:71]
v_mfma_f32_32x32x16_bf16 v[72:87], v[136:139], v[148:151], v[72:87]
ds_read_b128 v[120:123], v4 offset:32768
ds_read_b64_tr_b16 v[128:129], v14 offset:55296
ds_read_b64_tr_b16 v[130:131], v14 offset:55552
ds_read_b64_tr_b16 v[132:133], v17 offset:59392
ds_read_b64_tr_b16 v[134:135], v17 offset:59648
s_waitcnt lgkmcnt(10)
v_mfma_f32_32x32x16_bf16 v[56:71], v[96:99], v[88:91], v[56:71]
v_mfma_f32_32x32x16_bf16 v[72:87], v[88:91], v[100:103], v[72:87]
ds_read_b128 v[136:139], v5 offset:32768
ds_read_b64_tr_b16 v[144:145], v14 offset:56320
ds_read_b64_tr_b16 v[146:147], v14 offset:56576
ds_read_b64_tr_b16 v[148:149], v17 offset:60416
ds_read_b64_tr_b16 v[150:151], v17 offset:60672
s_waitcnt lgkmcnt(10)
v_mfma_f32_32x32x16_bf16 v[56:71], v[112:115], v[104:107], v[56:71]
v_mfma_f32_32x32x16_bf16 v[72:87], v[104:107], v[116:119], v[72:87]
s_waitcnt lgkmcnt(0)
s_barrier
ds_read_b128 v[88:91], v6 offset:0
ds_read_b64_tr_b16 v[96:97], v15 offset:20480
ds_read_b64_tr_b16 v[98:99], v15 offset:20736
ds_read_b64_tr_b16 v[100:101], v18 offset:24576
ds_read_b64_tr_b16 v[102:103], v18 offset:24832
s_waitcnt lgkmcnt(10)
v_mfma_f32_32x32x16_bf16 v[56:71], v[128:131], v[120:123], v[56:71]
v_mfma_f32_32x32x16_bf16 v[72:87], v[120:123], v[132:135], v[72:87]
ds_read_b128 v[104:107], v7 offset:0
ds_read_b64_tr_b16 v[112:113], v15 offset:21504
ds_read_b64_tr_b16 v[114:115], v15 offset:21760
ds_read_b64_tr_b16 v[116:117], v18 offset:25600
ds_read_b64_tr_b16 v[118:119], v18 offset:25856
s_waitcnt lgkmcnt(10)
v_mfma_f32_32x32x16_bf16 v[56:71], v[144:147], v[136:139], v[56:71]
v_mfma_f32_32x32x16_bf16 v[72:87], v[136:139], v[148:151], v[72:87]
ds_read_b128 v[120:123], v8 offset:0
ds_read_b64_tr_b16 v[128:129], v15 offset:22528
ds_read_b64_tr_b16 v[130:131], v15 offset:22784
ds_read_b64_tr_b16 v[132:133], v18 offset:26624
ds_read_b64_tr_b16 v[134:135], v18 offset:26880
s_waitcnt lgkmcnt(10)
v_mfma_f32_32x32x16_bf16 v[56:71], v[96:99], v[88:91], v[56:71]
v_mfma_f32_32x32x16_bf16 v[72:87], v[88:91], v[100:103], v[72:87]
ds_read_b128 v[136:139], v9 offset:0
ds_read_b64_tr_b16 v[144:145], v15 offset:23552
ds_read_b64_tr_b16 v[146:147], v15 offset:23808
ds_read_b64_tr_b16 v[148:149], v18 offset:27648
ds_read_b64_tr_b16 v[150:151], v18 offset:27904
s_waitcnt lgkmcnt(10)
v_mfma_f32_32x32x16_bf16 v[56:71], v[112:115], v[104:107], v[56:71]
v_mfma_f32_32x32x16_bf16 v[72:87], v[104:107], v[116:119], v[72:87]
s_waitcnt lgkmcnt(5)
v_mfma_f32_32x32x16_bf16 v[56:71], v[128:131], v[120:123], v[56:71]
v_mfma_f32_32x32x16_bf16 v[72:87], v[120:123], v[132:135], v[72:87]
s_waitcnt lgkmcnt(0)
v_mfma_f32_32x32x16_bf16 v[56:71], v[144:147], v[136:139], v[56:71]
v_mfma_f32_32x32x16_bf16 v[72:87], v[136:139], v[148:151], v[72:87]
ds_write_b32 v217, v218 offset:240
s_setprio 3
ds_read_b64_tr_b16 v[164:165], v170
ds_read_b64_tr_b16 v[166:167], v170 offset:128
s_nop 6
v_cvt_pk_bf16_f32 v96, v56, v57
v_cvt_pk_bf16_f32 v97, v58, v59
v_cvt_pk_bf16_f32 v98, v60, v61
v_cvt_pk_bf16_f32 v99, v62, v63
v_cvt_pk_bf16_f32 v100, v64, v65
v_cvt_pk_bf16_f32 v101, v66, v67
v_cvt_pk_bf16_f32 v102, v68, v69
v_cvt_pk_bf16_f32 v103, v70, v71
s_waitcnt lgkmcnt(0)
v_cmp_gt_u32 vcc, 16, v36
s_nop 1
v_cndmask_b32 v20, 0, v164, vcc
v_cndmask_b32 v24, v164, 0, vcc
v_cndmask_b32 v21, 0, v165, vcc
v_cndmask_b32 v25, v165, 0, vcc
v_cndmask_b32 v22, 0, v166, vcc
v_cndmask_b32 v26, v166, 0, vcc
v_cndmask_b32 v23, 0, v167, vcc
v_cndmask_b32 v27, v167, 0, vcc
s_nop 0
v_mfma_f32_32x32x16_bf16 v[120:135], v[20:23], v[96:99], 0
v_mfma_f32_32x32x16_bf16 v[120:135], v[24:27], v[100:103], v[120:135]
global_load_dword v37, v38, s[16:17] offset:4 sc1
global_load_dword v39, v38, s[52:53] offset:128 sc1
v_cvt_pk_bf16_f32 v104, v72, v73
v_cvt_pk_bf16_f32 v105, v74, v75
v_cvt_pk_bf16_f32 v106, v76, v77
v_cvt_pk_bf16_f32 v107, v78, v79
v_cvt_pk_bf16_f32 v108, v80, v81
v_cvt_pk_bf16_f32 v109, v82, v83
v_cvt_pk_bf16_f32 v110, v84, v85
v_cvt_pk_bf16_f32 v111, v86, v87
v_cmp_gt_u32 vcc, 16, v36
v_mov_b32 v153, 0x3f803f80
s_nop 0
v_cndmask_b32 v40, v153, v104, vcc
v_cndmask_b32 v48, v104, v153, vcc
v_cndmask_b32 v41, v153, v105, vcc
v_cndmask_b32 v49, v105, v153, vcc
v_cndmask_b32 v42, v153, v106, vcc
v_cndmask_b32 v50, v106, v153, vcc
v_cndmask_b32 v43, v153, v107, vcc
v_cndmask_b32 v51, v107, v153, vcc
v_cndmask_b32 v44, v153, v108, vcc
v_cndmask_b32 v52, v108, v153, vcc
v_cndmask_b32 v45, v153, v109, vcc
v_cndmask_b32 v53, v109, v153, vcc
v_cndmask_b32 v46, v153, v110, vcc
v_cndmask_b32 v54, v110, v153, vcc
v_cndmask_b32 v47, v153, v111, vcc
v_cndmask_b32 v55, v111, v153, vcc
v_max3_f32 v154, v120, v121, v122
v_min3_f32 v158, v120, v121, v122
v_max3_f32 v156, v128, v129, v130
v_min3_f32 v160, v128, v129, v130
v_max3_f32 v154, v154, v123, v124
v_min3_f32 v158, v158, v123, v124
v_max3_f32 v156, v156, v131, v132
v_min3_f32 v160, v160, v131, v132
v_max3_f32 v154, v154, v125, v126
v_min3_f32 v158, v158, v125, v126
v_max3_f32 v156, v156, v133, v134
v_min3_f32 v160, v160, v133, v134
v_max_f32 v154, v154, v127
v_min_f32 v158, v158, v127
v_max_f32 v156, v156, v135
v_min_f32 v160, v160, v135
v_mov_b32 v155, v154
v_mov_b32 v159, v158
v_mov_b32 v157, v156
v_mov_b32 v161, v160
v_permlane32_swap_b32 v154, v155
v_permlane32_swap_b32 v158, v159
v_permlane32_swap_b32 v156, v157
v_permlane32_swap_b32 v160, v161
v_max_f32 v154, v154, v155
v_min_f32 v158, v158, v159
v_max_f32 v156, v156, v157
v_min_f32 v160, v160, v161
v_mul_f32 v154, s29, v154
v_mul_f32 v158, s28, v158
v_mul_f32 v156, s29, v156
v_mul_f32 v160, s28, v160
v_pk_fma_f32 v[162:163], v[120:121], s[28:29], v[158:159] op_sel_hi:[1,0,0] neg_lo:[1,0,0] neg_hi:[1,0,0]
v_pk_fma_f32 v[120:121], v[120:121], s[28:29], v[154:155] op_sel_hi:[1,0,0]
v_pk_fma_f32 v[164:165], v[122:123], s[28:29], v[158:159] op_sel_hi:[1,0,0] neg_lo:[1,0,0] neg_hi:[1,0,0]
v_pk_fma_f32 v[122:123], v[122:123], s[28:29], v[154:155] op_sel_hi:[1,0,0]
v_pk_fma_f32 v[166:167], v[124:125], s[28:29], v[158:159] op_sel_hi:[1,0,0] neg_lo:[1,0,0] neg_hi:[1,0,0]
v_pk_fma_f32 v[124:125], v[124:125], s[28:29], v[154:155] op_sel_hi:[1,0,0]
v_pk_fma_f32 v[168:169], v[126:127], s[28:29], v[158:159] op_sel_hi:[1,0,0] neg_lo:[1,0,0] neg_hi:[1,0,0]
v_pk_fma_f32 v[126:127], v[126:127], s[28:29], v[154:155] op_sel_hi:[1,0,0]
v_pk_fma_f32 v[170:171], v[128:129], s[28:29], v[160:161] op_sel_hi:[1,0,0] neg_lo:[1,0,0] neg_hi:[1,0,0]
v_pk_fma_f32 v[128:129], v[128:129], s[28:29], v[156:157] op_sel_hi:[1,0,0]
v_pk_fma_f32 v[172:173], v[130:131], s[28:29], v[160:161] op_sel_hi:[1,0,0] neg_lo:[1,0,0] neg_hi:[1,0,0]
v_pk_fma_f32 v[130:131], v[130:131], s[28:29], v[156:157] op_sel_hi:[1,0,0]
v_pk_fma_f32 v[174:175], v[132:133], s[28:29], v[160:161] op_sel_hi:[1,0,0] neg_lo:[1,0,0] neg_hi:[1,0,0]
v_pk_fma_f32 v[132:133], v[132:133], s[28:29], v[156:157] op_sel_hi:[1,0,0]
v_pk_fma_f32 v[176:177], v[134:135], s[28:29], v[160:161] op_sel_hi:[1,0,0] neg_lo:[1,0,0] neg_hi:[1,0,0]
v_pk_fma_f32 v[134:135], v[134:135], s[28:29], v[156:157] op_sel_hi:[1,0,0]
v_exp_f32 v162, v162
v_exp_f32 v120, v120
v_exp_f32 v163, v163
v_exp_f32 v121, v121
v_exp_f32 v164, v164
v_exp_f32 v122, v122
v_exp_f32 v165, v165
v_exp_f32 v123, v123
v_exp_f32 v166, v166
v_exp_f32 v124, v124
v_exp_f32 v167, v167
v_exp_f32 v125, v125
v_exp_f32 v168, v168
v_exp_f32 v126, v126
v_exp_f32 v169, v169
v_exp_f32 v127, v127
v_exp_f32 v170, v170
v_exp_f32 v128, v128
v_exp_f32 v171, v171
v_exp_f32 v129, v129
v_exp_f32 v172, v172
v_exp_f32 v130, v130
v_exp_f32 v173, v173
v_exp_f32 v131, v131
v_exp_f32 v174, v174
v_exp_f32 v132, v132
v_exp_f32 v175, v175
v_exp_f32 v133, v133
v_exp_f32 v176, v176
v_exp_f32 v134, v134
v_exp_f32 v177, v177
v_exp_f32 v135, v135
ds_read_b32 v220, v221 offset:240
s_waitcnt vmcnt(2)
ds_write_b32 v217, v218 offset:352
v_pk_add_f32 v[154:155], v[120:121], v[122:123]
v_pk_add_f32 v[158:159], v[162:163], v[164:165]
v_pk_add_f32 v[156:157], v[128:129], v[130:131]
v_pk_add_f32 v[160:161], v[170:171], v[172:173]
v_pk_add_f32 v[154:155], v[154:155], v[124:125]
v_pk_add_f32 v[158:159], v[158:159], v[166:167]
v_pk_add_f32 v[156:157], v[156:157], v[132:133]
v_pk_add_f32 v[160:161], v[160:161], v[174:175]
v_pk_add_f32 v[154:155], v[154:155], v[126:127]
v_pk_add_f32 v[158:159], v[158:159], v[168:169]
v_pk_add_f32 v[156:157], v[156:157], v[134:135]
v_pk_add_f32 v[160:161], v[160:161], v[176:177]
v_add_f32 v154, v154, v155
v_add_f32 v158, v158, v159
v_add_f32 v156, v156, v157
v_add_f32 v160, v160, v161
v_mov_b32 v155, v154
v_mov_b32 v159, v158
v_mov_b32 v157, v156
v_mov_b32 v161, v160
v_permlane32_swap_b32 v154, v155
v_permlane32_swap_b32 v158, v159
v_permlane32_swap_b32 v156, v157
v_permlane32_swap_b32 v160, v161
v_add_f32 v154, v154, v155
v_add_f32 v158, v158, v159
v_add_f32 v156, v156, v157
v_add_f32 v160, v160, v161
v_rcp_f32 v154, v154
v_rcp_f32 v158, v158
v_rcp_f32 v156, v156
v_rcp_f32 v160, v160
v_pk_mul_f32 v[120:121], v[120:121], v[154:155] op_sel_hi:[1,0]
v_pk_mul_f32 v[162:163], v[162:163], v[158:159] op_sel_hi:[1,0]
v_pk_mul_f32 v[122:123], v[122:123], v[154:155] op_sel_hi:[1,0]
v_pk_mul_f32 v[164:165], v[164:165], v[158:159] op_sel_hi:[1,0]
v_pk_mul_f32 v[124:125], v[124:125], v[154:155] op_sel_hi:[1,0]
v_pk_mul_f32 v[166:167], v[166:167], v[158:159] op_sel_hi:[1,0]
v_pk_mul_f32 v[126:127], v[126:127], v[154:155] op_sel_hi:[1,0]
v_pk_mul_f32 v[168:169], v[168:169], v[158:159] op_sel_hi:[1,0]
v_pk_mul_f32 v[128:129], v[128:129], v[156:157] op_sel_hi:[1,0]
v_pk_mul_f32 v[170:171], v[170:171], v[160:161] op_sel_hi:[1,0]
v_pk_mul_f32 v[130:131], v[130:131], v[156:157] op_sel_hi:[1,0]
v_pk_mul_f32 v[172:173], v[172:173], v[160:161] op_sel_hi:[1,0]
v_pk_mul_f32 v[132:133], v[132:133], v[156:157] op_sel_hi:[1,0]
v_pk_mul_f32 v[174:175], v[174:175], v[160:161] op_sel_hi:[1,0]
v_pk_mul_f32 v[134:135], v[134:135], v[156:157] op_sel_hi:[1,0]
v_pk_mul_f32 v[176:177], v[176:177], v[160:161] op_sel_hi:[1,0]
v_cvt_pk_bf16_f32 v136, v120, v121
v_cvt_pk_bf16_f32 v140, v162, v163
v_cvt_pk_bf16_f32 v137, v122, v123
v_cvt_pk_bf16_f32 v141, v164, v165
v_cvt_pk_bf16_f32 v138, v124, v125
v_cvt_pk_bf16_f32 v142, v166, v167
v_cvt_pk_bf16_f32 v139, v126, v127
v_cvt_pk_bf16_f32 v143, v168, v169
v_cvt_pk_bf16_f32 v144, v128, v129
v_cvt_pk_bf16_f32 v148, v170, v171
v_cvt_pk_bf16_f32 v145, v130, v131
v_cvt_pk_bf16_f32 v149, v172, v173
v_cvt_pk_bf16_f32 v146, v132, v133
v_cvt_pk_bf16_f32 v150, v174, v175
v_cvt_pk_bf16_f32 v147, v134, v135
v_cvt_pk_bf16_f32 v151, v176, v177
v_mfma_f32_32x32x16_bf16 v[56:71], v[136:139], v[28:31], 0
v_mfma_f32_32x32x16_bf16 v[56:71], v[140:143], v[32:35], v[56:71]
v_mfma_f32_32x32x16_bf16 v[72:87], v[144:147], v[28:31], 0
v_mfma_f32_32x32x16_bf16 v[72:87], v[148:151], v[32:35], v[72:87]
s_mul_i32 s18, s3, 3072
s_add_u32 s18, s18, 0x14000
v_add_u32 v153, s18, v152
s_lshl_b32 s18, s3, 12
s_add_u32 s18, s18, 0x10c00
v_add_u32 v154, s18, v152
v_lshlrev_b32 v178, 2, v0
s_sub_u32 s18, s18, 1024
v_add_u32 v179, s18, v178
s_nop 0
v_cvt_pk_bf16_f32 v88, v56, v57
v_cvt_pk_bf16_f32 v89, v58, v59
v_cvt_pk_bf16_f32 v90, v60, v61
v_cvt_pk_bf16_f32 v91, v62, v63
v_cvt_pk_bf16_f32 v92, v64, v65
v_cvt_pk_bf16_f32 v93, v66, v67
v_cvt_pk_bf16_f32 v94, v68, v69
v_cvt_pk_bf16_f32 v95, v70, v71
v_cvt_pk_bf16_f32 v96, v72, v73
v_cvt_pk_bf16_f32 v97, v74, v75
v_cvt_pk_bf16_f32 v98, v76, v77
v_cvt_pk_bf16_f32 v99, v78, v79
v_cvt_pk_bf16_f32 v100, v80, v81
v_cvt_pk_bf16_f32 v101, v82, v83
v_cvt_pk_bf16_f32 v102, v84, v85
v_cvt_pk_bf16_f32 v103, v86, v87
v_mfma_f32_32x32x16_bf16 v[56:71], v[40:43], v[88:91], 0
v_mfma_f32_32x32x16_bf16 v[56:71], v[44:47], v[92:95], v[56:71]
v_mfma_f32_32x32x16_bf16 v[72:87], v[48:51], v[96:99], 0
v_mfma_f32_32x32x16_bf16 v[72:87], v[52:55], v[100:103], v[72:87]
s_lshl_b32 s18, s3, 10
s_add_u32 s18, s18, 0x14000
s_cmp_eq_u32 s3, 3
s_cselect_b32 s18, 0x10c00, s18
s_movk_i32 s19, 3072
s_cselect_b32 s19, 0x1000, s19
v_add_u32 v155, s18, v152
v_add_u32 v156, s19, v155
v_add_u32 v157, s19, v156
v_add_u32 v158, s19, v157
s_waitcnt lgkmcnt(0)
v_cmp_eq_u32 vcc, 0, v220
s_nop 3
s_cbranch_vccz K1_MLOK
FW10:
ds_read_b32 v219, v221 offset:240
s_waitcnt lgkmcnt(0)
v_cmp_eq_u32 vcc, 0, v219
s_nop 3
s_cbranch_vccz FW10_D
s_branch FW10
FW10_D:
K1_MLOK:
v_cmp_gt_u32 vcc, 32, v0
ds_write_b128 v153, v[56:59]
ds_write_b128 v153, v[60:63] offset:1024
v_cndmask_b32 v180, v72, v64, vcc
ds_write_b128 v153, v[80:83] offset:2048
ds_write_b128 v154, v[84:87]
ds_write_b32 v179, v180
ds_write_b32 v217, v218 offset:0
v_add_u32 v179, 0x10800, v178
s_nop 0
FW11:
ds_read_b32 v219, v216 offset:0
s_waitcnt lgkmcnt(0)
v_cmp_eq_u32 vcc, 0, v219
s_nop 3
s_cbranch_vccz FW11_D
s_branch FW11
FW11_D:
ds_read_b128 v[88:91], v155
ds_read_b128 v[92:95], v156
ds_read_b128 v[96:99], v157
ds_read_b128 v[100:103], v158
ds_read_b32 v104, v179 offset:0
ds_read_b32 v105, v179 offset:4096
ds_read_b32 v106, v179 offset:8192
ds_read_b32 v107, v179 offset:12288
s_mov_b32 s21, 0
K1_POLL:
s_waitcnt vmcnt(0)
v_readfirstlane_b32 s19, v37
s_nop 3
s_cmp_lg_u32 s19, 0
s_cbranch_scc1 K1_POLLDONE
s_add_u32 s21, s21, 1
s_cmp_lg_u32 s21, 4000
s_cbranch_scc1 K1_POLLMORE
v_mov_b32 v181, 1
s_mov_b64 exec, 1
global_atomic_add v182, v38, v181, s[16:17] sc0
s_waitcnt vmcnt(0)
s_mov_b64 exec, -1
v_readfirstlane_b32 s19, v182
s_nop 3
s_cmp_lg_u32 s19, 0
s_cbranch_scc1 K1_POLLMORE
v_mov_b32 v184, 0
v_mov_b32 v185, 0
v_mov_b32 v186, 0
v_mov_b32 v187, 0
v_lshlrev_b32 v188, 4, v0
s_lshl_b32 s18, s9, 12
buffer_store_dwordx4 v[184:187], v188, s[76:79], s18 offen offset:0 sc1
buffer_store_dwordx4 v[184:187], v188, s[76:79], s18 offen offset:1024 sc1
buffer_store_dwordx4 v[184:187], v188, s[76:79], s18 offen offset:2048 sc1
buffer_store_dwordx4 v[184:187], v188, s[76:79], s18 offen offset:3072 sc1
s_lshl_b32 s18, s9, 8
s_add_u32 s18, s18, 0x10000
s_mov_b64 exec, 0xffff
buffer_store_dwordx4 v[184:187], v188, s[76:79], s18 offen sc1
s_mov_b64 exec, -1
s_waitcnt vmcnt(0)
s_mov_b64 exec, 1
global_atomic_add v38, v181, s[16:17] offset:4
s_mov_b64 exec, -1
K1_POLLMORE:
s_sleep 8
global_load_dword v37, v38, s[16:17] offset:4 sc1
s_branch K1_POLL
K1_POLLDONE:
s_waitcnt lgkmcnt(0)
v_add_f32 v88, v88, v92
v_add_f32 v96, v96, v100
v_add_f32 v89, v89, v93
v_add_f32 v97, v97, v101
v_add_f32 v90, v90, v94
v_add_f32 v98, v98, v102
v_add_f32 v91, v91, v95
v_add_f32 v99, v99, v103
v_add_f32 v104, v104, v105
v_add_f32 v106, v106, v107
v_add_f32 v88, v88, v96
v_add_f32 v89, v89, v97
v_add_f32 v90, v90, v98
v_add_f32 v91, v91, v99
v_add_f32 v104, v104, v106
s_lshl_b32 s18, s9, 12
s_lshl_b32 s19, s3, 10
s_add_u32 s18, s18, s19
buffer_atomic_add_f32 v88, v178, s[76:79], s18 offen offset:0
buffer_atomic_add_f32 v89, v178, s[76:79], s18 offen offset:256
buffer_atomic_add_f32 v90, v178, s[76:79], s18 offen offset:512
buffer_atomic_add_f32 v91, v178, s[76:79], s18 offen offset:768
s_cmp_lg_u32 s3, 0
s_cbranch_scc1 K1_CEND
s_lshl_b32 s18, s9, 8
s_add_u32 s18, s18, 0x10000
buffer_atomic_add_f32 v104, v178, s[76:79], s18 offen
K1_CEND:
s_lshl_b32 s8, s4, 2
s_add_u32 s8, s8, s6
s_and_b32 s9, s5, 7
v_and_b32 v109, 3, v0
v_lshlrev_b32 v109, 2, v109
v_add_u32 v109, 0x17400, v109
s_lshl_b32 s18, s3, 2
s_add_u32 s18, s18, 0x17400
v_mov_b32 v110, s18
v_mov_b32 v111, 1
v_lshlrev_b32 v8, 4, v0
s_lshl_b32 s18, s3, 10
v_add_u32 v8, s18, v8
s_and_b32 s10, s3, 1
s_lshr_b32 s11, s3, 1
s_lshl_b32 s18, s8, 1
s_add_u32 s27, s18, s10
s_lshl_b32 s12, s27, 16
s_lshl_b32 s19, s11, 15
s_add_u32 s12, s12, s19
s_add_u32 s12, s12, 0x100000
v_lshlrev_b32 v3, 4, v0
v_mov_b32 v1, 0
v_lshlrev_b32 v60, 8, v0
v_lshlrev_b32 v61, 11, v0
v_mov_b32 v62, 1
s_and_b32 s28, s2, 7
s_lshl_b32 s28, s28, 11
s_add_u32 s28, s28, 0x1000000
s_and_b32 s18, s5, 7
s_lshl_b32 s29, s18, 8
s_add_u32 s29, s29, 0x1000000
s_mov_b32 s21, 0
EPC:
v_readfirstlane_b32 s20, v39
s_nop 3
s_cmp_lg_u32 s20, 0
s_cbranch_scc1 EPC_OK
s_add_u32 s21, s21, 1
s_cmp_gt_u32 s21, 0x30d40
s_cbranch_scc1 EPC_OK
global_load_dword v39, v1, s[52:53] offset:128 sc1
s_waitcnt vmcnt(0)
s_branch EPC
EPC_OK:
s_waitcnt vmcnt(0)
ds_write_b32 v110, v111 offset:16
s_cmp_lg_u32 s3, 0
s_cbranch_scc1 ARR_SKIP
FW12:
ds_read_b32 v6, v109 offset:16
s_waitcnt lgkmcnt(0)
v_cmp_eq_u32 vcc, 0, v6
s_nop 3
s_cbranch_vccz FW12_D
s_branch FW12
FW12_D:
s_mov_b32 exec_lo, 0xff
s_mov_b32 exec_hi, 0
buffer_atomic_add v62, v61, s[76:79], s29 offen
s_mov_b64 exec, -1
ds_write_b32 v109, v111 offset:320
s_branch ARR_GO
ARR_SKIP:
FW13:
ds_read_b32 v6, v109 offset:320
s_waitcnt lgkmcnt(0)
v_cmp_eq_u32 vcc, 0, v6
s_nop 3
s_cbranch_vccz FW13_D
s_branch FW13
FW13_D:
ARR_GO:
s_setprio 1
s_mov_b32 s7, s9
v_lshrrev_b32 v16, 3, v0
v_lshrrev_b32 v17, 2, v0
v_and_b32 v17, 4, v17
v_and_b32 v18, 7, v0
v_xor_b32 v17, v17, v18
v_lshlrev_b32 v17, 4, v17
v_lshl_or_b32 v16, v16, 10, v17
s_mov_b32 s92, s38
s_mov_b32 s93, s39
s_mov_b32 s94, 0x80000
s_mov_b32 s95, 0x00020000
s_lshr_b32 s19, s3, 1
s_and_b32 s20, s3, 1
s_lshl_b32 s21, s19, 13
s_lshl_b32 s22, s20, 17
s_add_u32 s21, s21, s22
s_lshl_b32 s22, s7, 7
s_add_u32 s21, s21, s22
s_lshl_b32 s22, s19, 10
s_lshl_b32 s23, s20, 14
s_add_u32 s22, s22, s23
s_add_u32 m0, s22, 0x8000
s_add_u32 s18, s21, 0x40000
buffer_load_dwordx4 v16, s[92:95], s18 offen lds
s_add_u32 m0, s22, 0x8800
s_add_u32 s18, s21, 0x44000
buffer_load_dwordx4 v16, s[92:95], s18 offen lds
s_add_u32 m0, s22, 0x9000
s_add_u32 s18, s21, 0x48000
buffer_load_dwordx4 v16, s[92:95], s18 offen lds
s_add_u32 m0, s22, 0x9800
s_add_u32 s18, s21, 0x4c000
buffer_load_dwordx4 v16, s[92:95], s18 offen lds
s_add_u32 m0, s22, 0xa000
s_add_u32 s18, s21, 0x50000
buffer_load_dwordx4 v16, s[92:95], s18 offen lds
s_add_u32 m0, s22, 0xa800
s_add_u32 s18, s21, 0x54000
buffer_load_dwordx4 v16, s[92:95], s18 offen lds
s_add_u32 m0, s22, 0xb000
s_add_u32 s18, s21, 0x58000
buffer_load_dwordx4 v16, s[92:95], s18 offen lds
s_add_u32 m0, s22, 0xb800
s_add_u32 s18, s21, 0x5c000
buffer_load_dwordx4 v16, s[92:95], s18 offen lds
v_lshrrev_b32 v10, 4, v0
v_lshrrev_b32 v11, 3, v0
v_and_b32 v11, 1, v11
v_lshl_or_b32 v10, v11, 3, v10
s_and_b32 s18, s3, 1
s_lshl_b32 s18, s18, 2
v_add_u32 v10, s18, v10
v_lshlrev_b32 v10, 4, v10
v_lshrrev_b32 v11, 2, v0
v_and_b32 v11, 1, v11
v_mul_u32_u24 v11, 544, v11
v_add_u32 v10, v10, v11
v_lshrrev_b32 v11, 1, v0
v_and_b32 v11, 1, v11
v_mul_u32_u24 v11, 272, v11
v_add_u32 v10, v10, v11
v_and_b32 v11, 1, v0
v_lshl_add_u32 v10, v11, 3, v10
s_lshr_b32 s18, s3, 1
s_and_b32 s18, s18, 1
s_mul_i32 s18, s18, 1088
s_add_u32 s18, s18, 0x1f800
v_add_u32 v10, s18, v10
s_mov_b32 s96, s50
s_mov_b32 s97, s51
s_mov_b32 s98, 0x400000
s_mov_b32 s99, 0x00020000
s_lshl_b32 s18, s3, 3
v_lshrrev_b32 v14, 3, v0
v_add_u32 v14, s18, v14
v_mul_u32_u24 v14, 1088, v14
v_lshrrev_b32 v15, 2, v0
v_and_b32 v15, 1, v15
v_mul_u32_u24 v15, 544, v15
v_add_u32 v14, v14, v15
v_lshrrev_b32 v15, 1, v0
v_and_b32 v15, 1, v15
v_mul_u32_u24 v15, 272, v15
v_add_u32 v14, v14, v15
v_and_b32 v15, 1, v0
v_lshl_add_u32 v14, v15, 3, v14
v_add_u32 v14, 0x1f900, v14
v_and_b32 v5, 31, v0
v_min_u32 v5, 16, v5
v_lshlrev_b32 v5, 4, v5
v_lshrrev_b32 v12, 5, v0
v_mul_u32_u24 v7, 272, v12
v_add_u32 v5, v5, v7
s_mul_i32 s18, s11, 17408
s_add_u32 s18, s18, 0x1f800
v_add_u32 v1, s18, v5
v_lshrrev_b32 v5, 2, v0
v_and_b32 v5, 3, v5
v_lshrrev_b32 v7, 1, v5
v_lshl_or_b32 v5, v12, 3, v5
v_lshlrev_b32 v5, 7, v5
v_lshl_or_b32 v5, v7, 6, v5
v_and_b32 v7, 16, v0
v_lshl_or_b32 v5, v7, 1, v5
v_and_b32 v7, 1, v0
v_lshl_or_b32 v5, v7, 4, v5
v_and_b32 v7, 2, v0
v_lshl_or_b32 v5, v7, 2, v5
s_lshl_b32 s18, s11, 15
s_add_u32 s18, s18, 0x0
v_add_u32 v2, s18, v5
v_xor_b32 v5, 64, v2
s_mov_b32 s20, 0x358637bd
s_lshl_b32 s18, s27, 1
s_add_u32 s18, s18, s11
s_lshl_b32 s18, s18, 7
s_add_u32 s18, s18, 0x1010000
v_add_u32 v60, s28, v60
v_mov_b32 v63, s18
v_cmp_eq_u32 vcc, 8, v0
s_nop 1
v_cndmask_b32 v60, v60, v63, vcc
v_subrev_u32 v63, 256, v63
v_cmp_eq_u32 vcc, 9, v0
s_nop 1
v_cndmask_b32 v60, v60, v63, vcc
v_lshlrev_b32 v65, 7, v0
v_subrev_u32 v63, 8, v0
v_and_b32 v61, 1, v63
v_lshlrev_b32 v61, 8, v61
v_lshrrev_b32 v62, 1, v63
v_lshl_add_u32 v61, v62, 7, v61
s_lshl_b32 s18, s8, 9
s_add_u32 s18, s18, 0x1010000
v_add_u32 v61, s18, v61
v_lshlrev_b32 v60, 8, v0
v_add_u32 v60, s28, v60
v_cmp_gt_u32 vcc, 8, v0
s_nop 1
v_cndmask_b32 v60, v61, v60, vcc
v_mov_b32 v61, 8
v_mov_b32 v62, 32
v_cndmask_b32 v61, v61, v62, vcc
v_lshlrev_b32 v62, 2, v63
v_add_u32 v62, 0x17570, v62
v_mov_b32 v63, 1
v_lshlrev_b32 v65, 7, v0
s_mov_b32 s21, 0
s_mov_b32 s19, 0
s_cmp_lg_u32 s3, 0
s_cbranch_scc1 P2_OTH
s_mov_b64 exec, 0xfff
buffer_load_dword v67, v60, s[76:79], 0 offen sc1
s_sleep 6
buffer_load_dword v68, v60, s[76:79], 0 offen sc1
s_sleep 6
FL_POLL:
s_mov_b64 exec, 0xfff
buffer_load_dword v69, v60, s[76:79], 0 offen sc1
s_add_u32 s21, s21, 1
s_waitcnt vmcnt(2)
s_mov_b64 exec, 0xfff
v_cmp_le_u32 vcc, v61, v67
s_cmp_gt_u32 s21, 0x30d40
s_cselect_b32 s44, 0xfff, vcc_lo
s_and_b32 s18, s44, 0xf00
s_nop 0
s_cbranch_scc0 FL_NP0_
s_mov_b64 exec, s[18:19]
ds_write_b32 v62, v63
FL_NP0_:
s_and_b32 s18, s44, 0xff
s_cmp_eq_u32 s18, 0xff
s_cbranch_scc1 FL_PASSED
s_mov_b64 exec, 0xfff
buffer_load_dword v67, v60, s[76:79], 0 offen sc1
s_add_u32 s21, s21, 1
s_waitcnt vmcnt(2)
s_mov_b64 exec, 0xfff
v_cmp_le_u32 vcc, v61, v68
s_cmp_gt_u32 s21, 0x30d40
s_cselect_b32 s44, 0xfff, vcc_lo
s_and_b32 s18, s44, 0xf00
s_nop 0
s_cbranch_scc0 FL_NP1_
s_mov_b64 exec, s[18:19]
ds_write_b32 v62, v63
FL_NP1_:
s_and_b32 s18, s44, 0xff
s_cmp_eq_u32 s18, 0xff
s_cbranch_scc1 FL_PASSED
s_mov_b64 exec, 0xfff
buffer_load_dword v68, v60, s[76:79], 0 offen sc1
s_add_u32 s21, s21, 1
s_waitcnt vmcnt(2)
s_mov_b64 exec, 0xfff
v_cmp_le_u32 vcc, v61, v69
s_cmp_gt_u32 s21, 0x30d40
s_cselect_b32 s44, 0xfff, vcc_lo
s_and_b32 s18, s44, 0xf00
s_nop 0
s_cbranch_scc0 FL_NP2_
s_mov_b64 exec, s[18:19]
ds_write_b32 v62, v63
FL_NP2_:
s_and_b32 s18, s44, 0xff
s_cmp_eq_u32 s18, 0xff
s_cbranch_scc0 FL_POLL
FL_PASSED:
s_mov_b64 exec, -1
ds_write_b32 v109, v111 offset:112
s_setprio 2
s_mov_b32 s22, 0x10000
buffer_load_dwordx4 v[104:107], v8, s[76:79], s22 offen sc1
s_mov_b32 s22, 0x0
buffer_load_dwordx4 v[72:75], v8, s[76:79], s22 offen sc1
s_mov_b32 s22, 0x8000
buffer_load_dwordx4 v[76:79], v8, s[76:79], s22 offen sc1
s_mov_b32 s22, 0x1000
buffer_load_dwordx4 v[80:83], v8, s[76:79], s22 offen sc1
s_mov_b32 s22, 0x9000
buffer_load_dwordx4 v[84:87], v8, s[76:79], s22 offen sc1
ds_write_b32 v110, v111 offset:336
s_and_b32 s18, s44, 0xf00
s_cmp_eq_u32 s18, 0xf00
s_cbranch_scc0 FL_Y
s_add_u32 s13, s12, 0x0
buffer_load_dwordx4 v[160:163], v3, s[76:79], s13 offen offset:0 sc1
buffer_load_dwordx4 v[164:167], v3, s[76:79], s13 offen offset:1024 sc1
buffer_load_dwordx4 v[168:171], v3, s[76:79], s13 offen offset:2048 sc1
buffer_load_dwordx4 v[172:175], v3, s[76:79], s13 offen offset:3072 sc1
s_add_u32 s13, s12, 0x1000
buffer_load_dwordx4 v[176:179], v3, s[76:79], s13 offen offset:0 sc1
buffer_load_dwordx4 v[180:183], v3, s[76:79], s13 offen offset:1024 sc1
buffer_load_dwordx4 v[184:187], v3, s[76:79], s13 offen offset:2048 sc1
buffer_load_dwordx4 v[188:191], v3, s[76:79], s13 offen offset:3072 sc1
s_add_u32 s13, s12, 0x2000
buffer_load_dwordx4 v[192:195], v3, s[76:79], s13 offen offset:0 sc1
buffer_load_dwordx4 v[196:199], v3, s[76:79], s13 offen offset:1024 sc1
buffer_load_dwordx4 v[200:203], v3, s[76:79], s13 offen offset:2048 sc1
buffer_load_dwordx4 v[204:207], v3, s[76:79], s13 offen offset:3072 sc1
s_add_u32 s13, s12, 0x3000
buffer_load_dwordx4 v[208:211], v3, s[76:79], s13 offen offset:0 sc1
buffer_load_dwordx4 v[212:215], v3, s[76:79], s13 offen offset:1024 sc1
buffer_load_dwordx4 v[216:219], v3, s[76:79], s13 offen offset:2048 sc1
buffer_load_dwordx4 v[220:223], v3, s[76:79], s13 offen offset:3072 sc1
FW14:
ds_read_b32 v6, v109 offset:288
s_waitcnt lgkmcnt(0)
v_cmp_eq_u32 vcc, 0, v6
s_nop 3
s_cbranch_vccz FW14_D
s_branch FW14
FW14_D:
s_waitcnt vmcnt(20)
v_cvt_pk_bf16_f32 v104, v104, v105
v_cvt_pk_bf16_f32 v105, v106, v107
ds_write_b64 v14, v[104:105]
s_waitcnt vmcnt(19)
v_cvt_pk_bf16_f32 v72, v72, v73
v_cvt_pk_bf16_f32 v73, v74, v75
ds_write_b64 v10, v[72:73] offset:0
s_waitcnt vmcnt(18)
v_cvt_pk_bf16_f32 v76, v76, v77
v_cvt_pk_bf16_f32 v77, v78, v79
ds_write_b64 v10, v[76:77] offset:17408
s_waitcnt vmcnt(17)
v_cvt_pk_bf16_f32 v80, v80, v81
v_cvt_pk_bf16_f32 v81, v82, v83
ds_write_b64 v10, v[80:81] offset:2176
s_waitcnt vmcnt(16)
v_cvt_pk_bf16_f32 v84, v84, v85
v_cvt_pk_bf16_f32 v85, v86, v87
ds_write_b64 v10, v[84:85] offset:19584
ds_write_b32 v110, v111 offset:144
s_branch P2_DONE
FL_Y:
s_mov_b64 exec, 0xf00
buffer_load_dword v67, v60, s[76:79], 0 offen sc1
s_mov_b64 exec, -1
FW15:
ds_read_b32 v6, v109 offset:288
s_waitcnt lgkmcnt(0)
v_cmp_eq_u32 vcc, 0, v6
s_nop 3
s_cbranch_vccz FW15_D
s_branch FW15
FW15_D:
s_waitcnt vmcnt(5)
v_cvt_pk_bf16_f32 v104, v104, v105
v_cvt_pk_bf16_f32 v105, v106, v107
ds_write_b64 v14, v[104:105]
s_waitcnt vmcnt(4)
v_cvt_pk_bf16_f32 v72, v72, v73
v_cvt_pk_bf16_f32 v73, v74, v75
ds_write_b64 v10, v[72:73] offset:0
s_waitcnt vmcnt(3)
v_cvt_pk_bf16_f32 v76, v76, v77
v_cvt_pk_bf16_f32 v77, v78, v79
ds_write_b64 v10, v[76:77] offset:17408
s_waitcnt vmcnt(2)
v_cvt_pk_bf16_f32 v80, v80, v81
v_cvt_pk_bf16_f32 v81, v82, v83
ds_write_b64 v10, v[80:81] offset:2176
s_waitcnt vmcnt(1)
v_cvt_pk_bf16_f32 v84, v84, v85
v_cvt_pk_bf16_f32 v85, v86, v87
ds_write_b64 v10, v[84:85] offset:19584
ds_write_b32 v110, v111 offset:144
s_add_u32 s21, s21, 1
s_waitcnt vmcnt(0)
s_mov_b64 exec, 0xf00
v_cmp_le_u32 vcc, v61, v67
s_cmp_gt_u32 s21, 0x30d40
s_cselect_b32 s44, 0xfff, vcc_lo
s_and_b32 s18, s44, 0xf00
s_nop 0
s_cbranch_scc0 FL_NP2
s_mov_b64 exec, s[18:19]
ds_write_b32 v62, v63
FL_NP2:
FL_POLL3:
s_and_b32 s18, s44, 0xf00
s_cmp_eq_u32 s18, 0xf00
s_cbranch_scc1 FL_Y2
s_mov_b64 exec, 0xf00
buffer_load_dword v67, v60, s[76:79], 0 offen sc1
s_add_u32 s21, s21, 1
s_waitcnt vmcnt(0)
s_mov_b64 exec, 0xf00
v_cmp_le_u32 vcc, v61, v67
s_cmp_gt_u32 s21, 0x30d40
s_cselect_b32 s44, 0xfff, vcc_lo
s_and_b32 s18, s44, 0xf00
s_nop 0
s_cbranch_scc0 FL_NP3
s_mov_b64 exec, s[18:19]
ds_write_b32 v62, v63
FL_NP3:
s_branch FL_POLL3
FL_Y2:
s_mov_b64 exec, -1
s_add_u32 s13, s12, 0x0
buffer_load_dwordx4 v[160:163], v3, s[76:79], s13 offen offset:0 sc1
buffer_load_dwordx4 v[164:167], v3, s[76:79], s13 offen offset:1024 sc1
buffer_load_dwordx4 v[168:171], v3, s[76:79], s13 offen offset:2048 sc1
buffer_load_dwordx4 v[172:175], v3, s[76:79], s13 offen offset:3072 sc1
s_add_u32 s13, s12, 0x1000
buffer_load_dwordx4 v[176:179], v3, s[76:79], s13 offen offset:0 sc1
buffer_load_dwordx4 v[180:183], v3, s[76:79], s13 offen offset:1024 sc1
buffer_load_dwordx4 v[184:187], v3, s[76:79], s13 offen offset:2048 sc1
buffer_load_dwordx4 v[188:191], v3, s[76:79], s13 offen offset:3072 sc1
s_add_u32 s13, s12, 0x2000
buffer_load_dwordx4 v[192:195], v3, s[76:79], s13 offen offset:0 sc1
buffer_load_dwordx4 v[196:199], v3, s[76:79], s13 offen offset:1024 sc1
buffer_load_dwordx4 v[200:203], v3, s[76:79], s13 offen offset:2048 sc1
buffer_load_dwordx4 v[204:207], v3, s[76:79], s13 offen offset:3072 sc1
s_add_u32 s13, s12, 0x3000
buffer_load_dwordx4 v[208:211], v3, s[76:79], s13 offen offset:0 sc1
buffer_load_dwordx4 v[212:215], v3, s[76:79], s13 offen offset:1024 sc1
buffer_load_dwordx4 v[216:219], v3, s[76:79], s13 offen offset:2048 sc1
buffer_load_dwordx4 v[220:223], v3, s[76:79], s13 offen offset:3072 sc1
s_branch P2_DONE
P2_OTH:
s_cmp_eq_u32 s3, 1
s_cselect_b32 s40, 1, 0
s_lshl_b32 s41, 1, s3
s_mov_b32 s42, 0
s_mov_b32 s43, 0
P2_POLL:
ds_read_b32 v7, v109 offset:112
ds_read_b32 v64, v109 offset:368
s_waitcnt lgkmcnt(0)
v_cmp_ne_u32 vcc, 0, v64
s_mov_b32 s44, vcc_lo
s_cmp_lg_u32 s43, 0
s_nop 1
s_cbranch_scc1 P2_NKV
v_cmp_eq_u32 vcc, 0, v7
s_nop 3
s_cbranch_vccnz P2_NKV
s_setprio 2
s_mov_b32 s22, 0x10000
buffer_load_dwordx4 v[104:107], v8, s[76:79], s22 offen sc1
s_mov_b32 s22, 0x0
buffer_load_dwordx4 v[72:75], v8, s[76:79], s22 offen sc1
s_mov_b32 s22, 0x8000
buffer_load_dwordx4 v[76:79], v8, s[76:79], s22 offen sc1
s_mov_b32 s22, 0x1000
buffer_load_dwordx4 v[80:83], v8, s[76:79], s22 offen sc1
s_mov_b32 s22, 0x9000
buffer_load_dwordx4 v[84:87], v8, s[76:79], s22 offen sc1
ds_write_b32 v110, v111 offset:336
s_cmp_lg_u32 s42, 0
s_cbranch_scc1 P2_KC
s_and_b32 s18, s44, s41
s_cbranch_scc0 P2_KC
s_add_u32 s13, s12, 0x0
buffer_load_dwordx4 v[160:163], v3, s[76:79], s13 offen offset:0 sc1
buffer_load_dwordx4 v[164:167], v3, s[76:79], s13 offen offset:1024 sc1
buffer_load_dwordx4 v[168:171], v3, s[76:79], s13 offen offset:2048 sc1
buffer_load_dwordx4 v[172:175], v3, s[76:79], s13 offen offset:3072 sc1
s_add_u32 s13, s12, 0x1000
buffer_load_dwordx4 v[176:179], v3, s[76:79], s13 offen offset:0 sc1
buffer_load_dwordx4 v[180:183], v3, s[76:79], s13 offen offset:1024 sc1
buffer_load_dwordx4 v[184:187], v3, s[76:79], s13 offen offset:2048 sc1
buffer_load_dwordx4 v[188:191], v3, s[76:79], s13 offen offset:3072 sc1
s_add_u32 s13, s12, 0x2000
buffer_load_dwordx4 v[192:195], v3, s[76:79], s13 offen offset:0 sc1
buffer_load_dwordx4 v[196:199], v3, s[76:79], s13 offen offset:1024 sc1
buffer_load_dwordx4 v[200:203], v3, s[76:79], s13 offen offset:2048 sc1
buffer_load_dwordx4 v[204:207], v3, s[76:79], s13 offen offset:3072 sc1
s_add_u32 s13, s12, 0x3000
buffer_load_dwordx4 v[208:211], v3, s[76:79], s13 offen offset:0 sc1
buffer_load_dwordx4 v[212:215], v3, s[76:79], s13 offen offset:1024 sc1
buffer_load_dwordx4 v[216:219], v3, s[76:79], s13 offen offset:2048 sc1
buffer_load_dwordx4 v[220:223], v3, s[76:79], s13 offen offset:3072 sc1
s_mov_b32 s42, 1
FW16:
ds_read_b32 v6, v109 offset:288
s_waitcnt lgkmcnt(0)
v_cmp_eq_u32 vcc, 0, v6
s_nop 3
s_cbranch_vccz FW16_D
s_branch FW16
FW16_D:
s_waitcnt vmcnt(20)
v_cvt_pk_bf16_f32 v104, v104, v105
v_cvt_pk_bf16_f32 v105, v106, v107
ds_write_b64 v14, v[104:105]
s_waitcnt vmcnt(19)
v_cvt_pk_bf16_f32 v72, v72, v73
v_cvt_pk_bf16_f32 v73, v74, v75
ds_write_b64 v10, v[72:73] offset:0
s_waitcnt vmcnt(18)
v_cvt_pk_bf16_f32 v76, v76, v77
v_cvt_pk_bf16_f32 v77, v78, v79
ds_write_b64 v10, v[76:77] offset:17408
s_waitcnt vmcnt(17)
v_cvt_pk_bf16_f32 v80, v80, v81
v_cvt_pk_bf16_f32 v81, v82, v83
ds_write_b64 v10, v[80:81] offset:2176
s_waitcnt vmcnt(16)
v_cvt_pk_bf16_f32 v84, v84, v85
v_cvt_pk_bf16_f32 v85, v86, v87
ds_write_b64 v10, v[84:85] offset:19584
ds_write_b32 v110, v111 offset:144
s_branch P2_KD
P2_KC:
FW17:
ds_read_b32 v6, v109 offset:288
s_waitcnt lgkmcnt(0)
v_cmp_eq_u32 vcc, 0, v6
s_nop 3
s_cbranch_vccz FW17_D
s_branch FW17
FW17_D:
s_waitcnt vmcnt(4)
v_cvt_pk_bf16_f32 v104, v104, v105
v_cvt_pk_bf16_f32 v105, v106, v107
ds_write_b64 v14, v[104:105]
s_waitcnt vmcnt(3)
v_cvt_pk_bf16_f32 v72, v72, v73
v_cvt_pk_bf16_f32 v73, v74, v75
ds_write_b64 v10, v[72:73] offset:0
s_waitcnt vmcnt(2)
v_cvt_pk_bf16_f32 v76, v76, v77
v_cvt_pk_bf16_f32 v77, v78, v79
ds_write_b64 v10, v[76:77] offset:17408
s_waitcnt vmcnt(1)
v_cvt_pk_bf16_f32 v80, v80, v81
v_cvt_pk_bf16_f32 v81, v82, v83
ds_write_b64 v10, v[80:81] offset:2176
s_waitcnt vmcnt(0)
v_cvt_pk_bf16_f32 v84, v84, v85
v_cvt_pk_bf16_f32 v85, v86, v87
ds_write_b64 v10, v[84:85] offset:19584
ds_write_b32 v110, v111 offset:144
P2_KD:
s_mov_b32 s43, 1
P2_NKV:
s_cmp_lg_u32 s42, 0
s_cbranch_scc1 P2_NPHI
s_and_b32 s18, s44, s41
s_cbranch_scc0 P2_NPHI
s_add_u32 s13, s12, 0x0
buffer_load_dwordx4 v[160:163], v3, s[76:79], s13 offen offset:0 sc1
buffer_load_dwordx4 v[164:167], v3, s[76:79], s13 offen offset:1024 sc1
buffer_load_dwordx4 v[168:171], v3, s[76:79], s13 offen offset:2048 sc1
buffer_load_dwordx4 v[172:175], v3, s[76:79], s13 offen offset:3072 sc1
s_add_u32 s13, s12, 0x1000
buffer_load_dwordx4 v[176:179], v3, s[76:79], s13 offen offset:0 sc1
buffer_load_dwordx4 v[180:183], v3, s[76:79], s13 offen offset:1024 sc1
buffer_load_dwordx4 v[184:187], v3, s[76:79], s13 offen offset:2048 sc1
buffer_load_dwordx4 v[188:191], v3, s[76:79], s13 offen offset:3072 sc1
s_add_u32 s13, s12, 0x2000
buffer_load_dwordx4 v[192:195], v3, s[76:79], s13 offen offset:0 sc1
buffer_load_dwordx4 v[196:199], v3, s[76:79], s13 offen offset:1024 sc1
buffer_load_dwordx4 v[200:203], v3, s[76:79], s13 offen offset:2048 sc1
buffer_load_dwordx4 v[204:207], v3, s[76:79], s13 offen offset:3072 sc1
s_add_u32 s13, s12, 0x3000
buffer_load_dwordx4 v[208:211], v3, s[76:79], s13 offen offset:0 sc1
buffer_load_dwordx4 v[212:215], v3, s[76:79], s13 offen offset:1024 sc1
buffer_load_dwordx4 v[216:219], v3, s[76:79], s13 offen offset:2048 sc1
buffer_load_dwordx4 v[220:223], v3, s[76:79], s13 offen offset:3072 sc1
s_mov_b32 s42, 1
P2_NPHI:
s_and_b32 s18, s40, s44
s_cbranch_scc0 P2_NP0
s_sub_u32 s18, s12, 0x10000
buffer_load_dword v66, v65, s[76:79], s18 offen sc1
s_add_u32 s18, s18, 0x2000
buffer_load_dword v66, v65, s[76:79], s18 offen sc1
s_add_u32 s18, s18, 0x2000
buffer_load_dword v66, v65, s[76:79], s18 offen sc1
s_add_u32 s18, s18, 0x2000
buffer_load_dword v66, v65, s[76:79], s18 offen sc1
s_mov_b32 s40, 0
P2_NP0:
s_and_b32 s18, s42, s43
s_cbranch_scc0 P2_POLL
P2_DONE:
FW18:
ds_read_b32 v6, v109 offset:144
s_waitcnt lgkmcnt(0)
v_cmp_eq_u32 vcc, 0, v6
s_nop 3
s_cbranch_vccz FW18_D
s_branch FW18
FW18_D:
ds_read_b128 v[72:75], v1 offset:0
ds_read_b128 v[76:79], v1 offset:544
s_waitcnt lgkmcnt(0)
s_waitcnt vmcnt(14)
v_mfma_f32_32x32x16_bf16 v[40:55], v[72:75], v[160:163], 0
ds_read_b128 v[80:83], v1 offset:1088
ds_read_b128 v[84:87], v1 offset:1632
v_mfma_f32_32x32x16_bf16 v[40:55], v[76:79], v[164:167], v[40:55]
s_add_u32 s13, s12, 0x4000
buffer_load_dwordx4 v[160:163], v3, s[76:79], s13 offen offset:0 sc1
buffer_load_dwordx4 v[164:167], v3, s[76:79], s13 offen offset:1024 sc1
s_waitcnt lgkmcnt(0)
s_waitcnt vmcnt(14)
v_mfma_f32_32x32x16_bf16 v[56:71], v[80:83], v[168:171], 0
ds_read_b128 v[88:91], v1 offset:2176
ds_read_b128 v[92:95], v1 offset:2720
s_nop 3
v_add_f32 v4, s20, v48
v_rcp_f32 v4, v4
v_mfma_f32_32x32x16_bf16 v[56:71], v[84:87], v[172:175], v[56:71]
ds_read_b64_tr_b16 v[128:129], v2 offset:0
ds_read_b64_tr_b16 v[130:131], v2 offset:512
v_mul_f32 v40, v40, v4
v_mul_f32 v41, v41, v4
v_mul_f32 v42, v42, v4
v_mul_f32 v43, v43, v4
ds_read_b64_tr_b16 v[132:133], v5 offset:0
ds_read_b64_tr_b16 v[134:135], v5 offset:512
v_mul_f32 v44, v44, v4
v_mul_f32 v45, v45, v4
v_mul_f32 v46, v46, v4
v_mul_f32 v47, v47, v4
v_cvt_pk_bf16_f32 v40, v40, v41
v_cvt_pk_bf16_f32 v41, v42, v43
v_cvt_pk_bf16_f32 v42, v44, v45
v_cvt_pk_bf16_f32 v43, v46, v47
s_add_u32 s13, s12, 0x4000
buffer_load_dwordx4 v[168:171], v3, s[76:79], s13 offen offset:2048 sc1
buffer_load_dwordx4 v[172:175], v3, s[76:79], s13 offen offset:3072 sc1
ds_read_b32 v7, v109 offset:160
s_waitcnt lgkmcnt(5)
s_waitcnt vmcnt(14)
v_mfma_f32_32x32x16_bf16 v[112:127], v[88:91], v[176:179], 0
ds_read_b128 v[72:75], v1 offset:3264
ds_read_b128 v[76:79], v1 offset:3808
v_add_f32 v4, s20, v64
v_rcp_f32 v4, v4
v_mfma_f32_32x32x16_bf16 v[112:127], v[92:95], v[180:183], v[112:127]
ds_read_b64_tr_b16 v[144:145], v2 offset:2048
ds_read_b64_tr_b16 v[146:147], v2 offset:2560
v_mul_f32 v56, v56, v4
v_mul_f32 v57, v57, v4
v_mul_f32 v58, v58, v4
v_mul_f32 v59, v59, v4
s_waitcnt lgkmcnt(7)
v_mfma_f32_32x32x16_bf16 v[8:23], v[128:131], v[40:43], 0
ds_read_b64_tr_b16 v[148:149], v5 offset:2048
ds_read_b64_tr_b16 v[150:151], v5 offset:2560
v_mul_f32 v60, v60, v4
v_mul_f32 v61, v61, v4
v_mul_f32 v62, v62, v4
v_mul_f32 v63, v63, v4
s_waitcnt lgkmcnt(7)
v_mfma_f32_32x32x16_bf16 v[24:39], v[132:135], v[40:43], 0
v_cvt_pk_bf16_f32 v56, v56, v57
v_cvt_pk_bf16_f32 v57, v58, v59
v_cvt_pk_bf16_f32 v58, v60, v61
v_cvt_pk_bf16_f32 v59, v62, v63
s_add_u32 s13, s12, 0x5000
buffer_load_dwordx4 v[176:179], v3, s[76:79], s13 offen offset:0 sc1
buffer_load_dwordx4 v[180:183], v3, s[76:79], s13 offen offset:1024 sc1
s_waitcnt lgkmcnt(6)
v_cmp_eq_u32 vcc, 0, v7
s_cbranch_vccnz KVS1
KVB1:
s_waitcnt lgkmcnt(4)
s_waitcnt vmcnt(14)
v_mfma_f32_32x32x16_bf16 v[40:55], v[72:75], v[184:187], 0
ds_read_b128 v[80:83], v1 offset:4352
ds_read_b128 v[84:87], v1 offset:4896
v_add_f32 v4, s20, v120
v_rcp_f32 v4, v4
v_mfma_f32_32x32x16_bf16 v[40:55], v[76:79], v[188:191], v[40:55]
ds_read_b64_tr_b16 v[128:129], v2 offset:4096
ds_read_b64_tr_b16 v[130:131], v2 offset:4608
v_mul_f32 v112, v112, v4
v_mul_f32 v113, v113, v4
v_mul_f32 v114, v114, v4
v_mul_f32 v115, v115, v4
s_waitcnt lgkmcnt(6)
v_mfma_f32_32x32x16_bf16 v[8:23], v[144:147], v[56:59], v[8:23]
ds_read_b64_tr_b16 v[132:133], v5 offset:4096
ds_read_b64_tr_b16 v[134:135], v5 offset:4608
v_mul_f32 v116, v116, v4
v_mul_f32 v117, v117, v4
v_mul_f32 v118, v118, v4
v_mul_f32 v119, v119, v4
s_waitcnt lgkmcnt(6)
v_mfma_f32_32x32x16_bf16 v[24:39], v[148:151], v[56:59], v[24:39]
v_cvt_pk_bf16_f32 v112, v112, v113
v_cvt_pk_bf16_f32 v113, v114, v115
v_cvt_pk_bf16_f32 v114, v116, v117
v_cvt_pk_bf16_f32 v115, v118, v119
s_add_u32 s13, s12, 0x5000
buffer_load_dwordx4 v[184:187], v3, s[76:79], s13 offen offset:2048 sc1
buffer_load_dwordx4 v[188:191], v3, s[76:79], s13 offen offset:3072 sc1
s_waitcnt lgkmcnt(4)
s_waitcnt vmcnt(14)
v_mfma_f32_32x32x16_bf16 v[56:71], v[80:83], v[192:195], 0
ds_read_b128 v[88:91], v1 offset:5440
ds_read_b128 v[92:95], v1 offset:5984
v_add_f32 v4, s20, v48
v_rcp_f32 v4, v4
v_mfma_f32_32x32x16_bf16 v[56:71], v[84:87], v[196:199], v[56:71]
ds_read_b64_tr_b16 v[144:145], v2 offset:6144
ds_read_b64_tr_b16 v[146:147], v2 offset:6656
v_mul_f32 v40, v40, v4
v_mul_f32 v41, v41, v4
v_mul_f32 v42, v42, v4
v_mul_f32 v43, v43, v4
s_waitcnt lgkmcnt(6)
v_mfma_f32_32x32x16_bf16 v[8:23], v[128:131], v[112:115], v[8:23]
ds_read_b64_tr_b16 v[148:149], v5 offset:6144
ds_read_b64_tr_b16 v[150:151], v5 offset:6656
v_mul_f32 v44, v44, v4
v_mul_f32 v45, v45, v4
v_mul_f32 v46, v46, v4
v_mul_f32 v47, v47, v4
s_waitcnt lgkmcnt(6)
v_mfma_f32_32x32x16_bf16 v[24:39], v[132:135], v[112:115], v[24:39]
v_cvt_pk_bf16_f32 v40, v40, v41
v_cvt_pk_bf16_f32 v41, v42, v43
v_cvt_pk_bf16_f32 v42, v44, v45
v_cvt_pk_bf16_f32 v43, v46, v47
s_add_u32 s13, s12, 0x6000
buffer_load_dwordx4 v[192:195], v3, s[76:79], s13 offen offset:0 sc1
buffer_load_dwordx4 v[196:199], v3, s[76:79], s13 offen offset:1024 sc1
s_waitcnt lgkmcnt(4)
s_waitcnt vmcnt(14)
v_mfma_f32_32x32x16_bf16 v[112:127], v[88:91], v[200:203], 0
ds_read_b128 v[72:75], v1 offset:6528
ds_read_b128 v[76:79], v1 offset:7072
v_add_f32 v4, s20, v64
v_rcp_f32 v4, v4
v_mfma_f32_32x32x16_bf16 v[112:127], v[92:95], v[204:207], v[112:127]
ds_read_b64_tr_b16 v[128:129], v2 offset:8192
ds_read_b64_tr_b16 v[130:131], v2 offset:8704
v_mul_f32 v56, v56, v4
v_mul_f32 v57, v57, v4
v_mul_f32 v58, v58, v4
v_mul_f32 v59, v59, v4
s_waitcnt lgkmcnt(6)
v_mfma_f32_32x32x16_bf16 v[8:23], v[144:147], v[40:43], v[8:23]
ds_read_b64_tr_b16 v[132:133], v5 offset:8192
ds_read_b64_tr_b16 v[134:135], v5 offset:8704
v_mul_f32 v60, v60, v4
v_mul_f32 v61, v61, v4
v_mul_f32 v62, v62, v4
v_mul_f32 v63, v63, v4
s_waitcnt lgkmcnt(6)
v_mfma_f32_32x32x16_bf16 v[24:39], v[148:151], v[40:43], v[24:39]
v_cvt_pk_bf16_f32 v56, v56, v57
v_cvt_pk_bf16_f32 v57, v58, v59
v_cvt_pk_bf16_f32 v58, v60, v61
v_cvt_pk_bf16_f32 v59, v62, v63
s_add_u32 s13, s12, 0x6000
buffer_load_dwordx4 v[200:203], v3, s[76:79], s13 offen offset:2048 sc1
buffer_load_dwordx4 v[204:207], v3, s[76:79], s13 offen offset:3072 sc1
ds_read_b32 v7, v109 offset:176
s_waitcnt lgkmcnt(5)
s_waitcnt vmcnt(14)
v_mfma_f32_32x32x16_bf16 v[40:55], v[72:75], v[208:211], 0
ds_read_b128 v[80:83], v1 offset:7616
ds_read_b128 v[84:87], v1 offset:8160
v_add_f32 v4, s20, v120
v_rcp_f32 v4, v4
v_mfma_f32_32x32x16_bf16 v[40:55], v[76:79], v[212:215], v[40:55]
ds_read_b64_tr_b16 v[144:145], v2 offset:10240
ds_read_b64_tr_b16 v[146:147], v2 offset:10752
v_mul_f32 v112, v112, v4
v_mul_f32 v113, v113, v4
v_mul_f32 v114, v114, v4
v_mul_f32 v115, v115, v4
s_waitcnt lgkmcnt(7)
v_mfma_f32_32x32x16_bf16 v[8:23], v[128:131], v[56:59], v[8:23]
ds_read_b64_tr_b16 v[148:149], v5 offset:10240
ds_read_b64_tr_b16 v[150:151], v5 offset:10752
v_mul_f32 v116, v116, v4
v_mul_f32 v117, v117, v4
v_mul_f32 v118, v118, v4
v_mul_f32 v119, v119, v4
s_waitcnt lgkmcnt(7)
v_mfma_f32_32x32x16_bf16 v[24:39], v[132:135], v[56:59], v[24:39]
v_cvt_pk_bf16_f32 v112, v112, v113
v_cvt_pk_bf16_f32 v113, v114, v115
v_cvt_pk_bf16_f32 v114, v116, v117
v_cvt_pk_bf16_f32 v115, v118, v119
s_add_u32 s13, s12, 0x7000
buffer_load_dwordx4 v[208:211], v3, s[76:79], s13 offen offset:0 sc1
buffer_load_dwordx4 v[212:215], v3, s[76:79], s13 offen offset:1024 sc1
s_waitcnt lgkmcnt(6)
v_cmp_eq_u32 vcc, 0, v7
s_cbranch_vccnz KVS2
KVB2:
s_waitcnt lgkmcnt(4)
s_waitcnt vmcnt(14)
v_mfma_f32_32x32x16_bf16 v[56:71], v[80:83], v[216:219], 0
ds_read_b128 v[88:91], v1 offset:8704
ds_read_b128 v[92:95], v1 offset:9248
v_add_f32 v4, s20, v48
v_rcp_f32 v4, v4
v_mfma_f32_32x32x16_bf16 v[56:71], v[84:87], v[220:223], v[56:71]
ds_read_b64_tr_b16 v[128:129], v2 offset:12288
ds_read_b64_tr_b16 v[130:131], v2 offset:12800
v_mul_f32 v40, v40, v4
v_mul_f32 v41, v41, v4
v_mul_f32 v42, v42, v4
v_mul_f32 v43, v43, v4
s_waitcnt lgkmcnt(6)
v_mfma_f32_32x32x16_bf16 v[8:23], v[144:147], v[112:115], v[8:23]
ds_read_b64_tr_b16 v[132:133], v5 offset:12288
ds_read_b64_tr_b16 v[134:135], v5 offset:12800
v_mul_f32 v44, v44, v4
v_mul_f32 v45, v45, v4
v_mul_f32 v46, v46, v4
v_mul_f32 v47, v47, v4
s_waitcnt lgkmcnt(6)
v_mfma_f32_32x32x16_bf16 v[24:39], v[148:151], v[112:115], v[24:39]
v_cvt_pk_bf16_f32 v40, v40, v41
v_cvt_pk_bf16_f32 v41, v42, v43
v_cvt_pk_bf16_f32 v42, v44, v45
v_cvt_pk_bf16_f32 v43, v46, v47
s_add_u32 s13, s12, 0x7000
buffer_load_dwordx4 v[216:219], v3, s[76:79], s13 offen offset:2048 sc1
buffer_load_dwordx4 v[220:223], v3, s[76:79], s13 offen offset:3072 sc1
s_waitcnt lgkmcnt(4)
s_waitcnt vmcnt(14)
v_mfma_f32_32x32x16_bf16 v[112:127], v[88:91], v[160:163], 0
ds_read_b128 v[72:75], v1 offset:9792
ds_read_b128 v[76:79], v1 offset:10336
v_add_f32 v4, s20, v64
v_rcp_f32 v4, v4
v_mfma_f32_32x32x16_bf16 v[112:127], v[92:95], v[164:167], v[112:127]
ds_read_b64_tr_b16 v[144:145], v2 offset:14336
ds_read_b64_tr_b16 v[146:147], v2 offset:14848
v_mul_f32 v56, v56, v4
v_mul_f32 v57, v57, v4
v_mul_f32 v58, v58, v4
v_mul_f32 v59, v59, v4
s_waitcnt lgkmcnt(6)
v_mfma_f32_32x32x16_bf16 v[8:23], v[128:131], v[40:43], v[8:23]
ds_read_b64_tr_b16 v[148:149], v5 offset:14336
ds_read_b64_tr_b16 v[150:151], v5 offset:14848
v_mul_f32 v60, v60, v4
v_mul_f32 v61, v61, v4
v_mul_f32 v62, v62, v4
v_mul_f32 v63, v63, v4
s_waitcnt lgkmcnt(6)
v_mfma_f32_32x32x16_bf16 v[24:39], v[132:135], v[40:43], v[24:39]
v_cvt_pk_bf16_f32 v56, v56, v57
v_cvt_pk_bf16_f32 v57, v58, v59
v_cvt_pk_bf16_f32 v58, v60, v61
v_cvt_pk_bf16_f32 v59, v62, v63
s_waitcnt lgkmcnt(4)
s_waitcnt vmcnt(12)
v_mfma_f32_32x32x16_bf16 v[40:55], v[72:75], v[168:171], 0
ds_read_b128 v[80:83], v1 offset:10880
ds_read_b128 v[84:87], v1 offset:11424
v_add_f32 v4, s20, v120
v_rcp_f32 v4, v4
v_mfma_f32_32x32x16_bf16 v[40:55], v[76:79], v[172:175], v[40:55]
ds_read_b64_tr_b16 v[128:129], v2 offset:16384
ds_read_b64_tr_b16 v[130:131], v2 offset:16896
v_mul_f32 v112, v112, v4
v_mul_f32 v113, v113, v4
v_mul_f32 v114, v114, v4
v_mul_f32 v115, v115, v4
s_waitcnt lgkmcnt(6)
v_mfma_f32_32x32x16_bf16 v[8:23], v[144:147], v[56:59], v[8:23]
ds_read_b64_tr_b16 v[132:133], v5 offset:16384
ds_read_b64_tr_b16 v[134:135], v5 offset:16896
v_mul_f32 v116, v116, v4
v_mul_f32 v117, v117, v4
v_mul_f32 v118, v118, v4
v_mul_f32 v119, v119, v4
s_waitcnt lgkmcnt(6)
v_mfma_f32_32x32x16_bf16 v[24:39], v[148:151], v[56:59], v[24:39]
v_cvt_pk_bf16_f32 v112, v112, v113
v_cvt_pk_bf16_f32 v113, v114, v115
v_cvt_pk_bf16_f32 v114, v116, v117
v_cvt_pk_bf16_f32 v115, v118, v119
ds_read_b32 v7, v109 offset:192
s_waitcnt lgkmcnt(5)
s_waitcnt vmcnt(10)
v_mfma_f32_32x32x16_bf16 v[56:71], v[80:83], v[176:179], 0
ds_read_b128 v[88:91], v1 offset:11968
ds_read_b128 v[92:95], v1 offset:12512
v_add_f32 v4, s20, v48
v_rcp_f32 v4, v4
v_mfma_f32_32x32x16_bf16 v[56:71], v[84:87], v[180:183], v[56:71]
ds_read_b64_tr_b16 v[144:145], v2 offset:18432
ds_read_b64_tr_b16 v[146:147], v2 offset:18944
v_mul_f32 v40, v40, v4
v_mul_f32 v41, v41, v4
v_mul_f32 v42, v42, v4
v_mul_f32 v43, v43, v4
s_waitcnt lgkmcnt(7)
v_mfma_f32_32x32x16_bf16 v[8:23], v[128:131], v[112:115], v[8:23]
ds_read_b64_tr_b16 v[148:149], v5 offset:18432
ds_read_b64_tr_b16 v[150:151], v5 offset:18944
v_mul_f32 v44, v44, v4
v_mul_f32 v45, v45, v4
v_mul_f32 v46, v46, v4
v_mul_f32 v47, v47, v4
s_waitcnt lgkmcnt(7)
v_mfma_f32_32x32x16_bf16 v[24:39], v[132:135], v[112:115], v[24:39]
v_cvt_pk_bf16_f32 v40, v40, v41
v_cvt_pk_bf16_f32 v41, v42, v43
v_cvt_pk_bf16_f32 v42, v44, v45
v_cvt_pk_bf16_f32 v43, v46, v47
s_waitcnt lgkmcnt(6)
v_cmp_eq_u32 vcc, 0, v7
s_cbranch_vccnz KVS3
KVB3:
s_waitcnt lgkmcnt(4)
s_waitcnt vmcnt(8)
v_mfma_f32_32x32x16_bf16 v[112:127], v[88:91], v[184:187], 0
ds_read_b128 v[72:75], v1 offset:13056
ds_read_b128 v[76:79], v1 offset:13600
v_add_f32 v4, s20, v64
v_rcp_f32 v4, v4
v_mfma_f32_32x32x16_bf16 v[112:127], v[92:95], v[188:191], v[112:127]
ds_read_b64_tr_b16 v[128:129], v2 offset:20480
ds_read_b64_tr_b16 v[130:131], v2 offset:20992
v_mul_f32 v56, v56, v4
v_mul_f32 v57, v57, v4
v_mul_f32 v58, v58, v4
v_mul_f32 v59, v59, v4
s_waitcnt lgkmcnt(6)
v_mfma_f32_32x32x16_bf16 v[8:23], v[144:147], v[40:43], v[8:23]
ds_read_b64_tr_b16 v[132:133], v5 offset:20480
ds_read_b64_tr_b16 v[134:135], v5 offset:20992
v_mul_f32 v60, v60, v4
v_mul_f32 v61, v61, v4
v_mul_f32 v62, v62, v4
v_mul_f32 v63, v63, v4
s_waitcnt lgkmcnt(6)
v_mfma_f32_32x32x16_bf16 v[24:39], v[148:151], v[40:43], v[24:39]
v_cvt_pk_bf16_f32 v56, v56, v57
v_cvt_pk_bf16_f32 v57, v58, v59
v_cvt_pk_bf16_f32 v58, v60, v61
v_cvt_pk_bf16_f32 v59, v62, v63
s_waitcnt lgkmcnt(4)
s_waitcnt vmcnt(6)
v_mfma_f32_32x32x16_bf16 v[40:55], v[72:75], v[192:195], 0
ds_read_b128 v[80:83], v1 offset:14144
ds_read_b128 v[84:87], v1 offset:14688
v_add_f32 v4, s20, v120
v_rcp_f32 v4, v4
v_mfma_f32_32x32x16_bf16 v[40:55], v[76:79], v[196:199], v[40:55]
ds_read_b64_tr_b16 v[144:145], v2 offset:22528
ds_read_b64_tr_b16 v[146:147], v2 offset:23040
v_mul_f32 v112, v112, v4
v_mul_f32 v113, v113, v4
v_mul_f32 v114, v114, v4
v_mul_f32 v115, v115, v4
s_waitcnt lgkmcnt(6)
v_mfma_f32_32x32x16_bf16 v[8:23], v[128:131], v[56:59], v[8:23]
ds_read_b64_tr_b16 v[148:149], v5 offset:22528
ds_read_b64_tr_b16 v[150:151], v5 offset:23040
v_mul_f32 v116, v116, v4
v_mul_f32 v117, v117, v4
v_mul_f32 v118, v118, v4
v_mul_f32 v119, v119, v4
s_waitcnt lgkmcnt(6)
v_mfma_f32_32x32x16_bf16 v[24:39], v[132:135], v[56:59], v[24:39]
v_cvt_pk_bf16_f32 v112, v112, v113
v_cvt_pk_bf16_f32 v113, v114, v115
v_cvt_pk_bf16_f32 v114, v116, v117
v_cvt_pk_bf16_f32 v115, v118, v119
s_waitcnt lgkmcnt(4)
s_waitcnt vmcnt(4)
v_mfma_f32_32x32x16_bf16 v[56:71], v[80:83], v[200:203], 0
ds_read_b128 v[88:91], v1 offset:15232
ds_read_b128 v[92:95], v1 offset:15776
v_add_f32 v4, s20, v48
v_rcp_f32 v4, v4
v_mfma_f32_32x32x16_bf16 v[56:71], v[84:87], v[204:207], v[56:71]
ds_read_b64_tr_b16 v[128:129], v2 offset:24576
ds_read_b64_tr_b16 v[130:131], v2 offset:25088
v_mul_f32 v40, v40, v4
v_mul_f32 v41, v41, v4
v_mul_f32 v42, v42, v4
v_mul_f32 v43, v43, v4
s_waitcnt lgkmcnt(6)
v_mfma_f32_32x32x16_bf16 v[8:23], v[144:147], v[112:115], v[8:23]
ds_read_b64_tr_b16 v[132:133], v5 offset:24576
ds_read_b64_tr_b16 v[134:135], v5 offset:25088
v_mul_f32 v44, v44, v4
v_mul_f32 v45, v45, v4
v_mul_f32 v46, v46, v4
v_mul_f32 v47, v47, v4
s_waitcnt lgkmcnt(6)
v_mfma_f32_32x32x16_bf16 v[24:39], v[148:151], v[112:115], v[24:39]
v_cvt_pk_bf16_f32 v40, v40, v41
v_cvt_pk_bf16_f32 v41, v42, v43
v_cvt_pk_bf16_f32 v42, v44, v45
v_cvt_pk_bf16_f32 v43, v46, v47
s_waitcnt lgkmcnt(4)
s_waitcnt vmcnt(2)
v_mfma_f32_32x32x16_bf16 v[112:127], v[88:91], v[208:211], 0
ds_read_b128 v[72:75], v1 offset:16320
ds_read_b128 v[76:79], v1 offset:16864
v_add_f32 v4, s20, v64
v_rcp_f32 v4, v4
v_mfma_f32_32x32x16_bf16 v[112:127], v[92:95], v[212:215], v[112:127]
ds_read_b64_tr_b16 v[144:145], v2 offset:26624
ds_read_b64_tr_b16 v[146:147], v2 offset:27136
v_mul_f32 v56, v56, v4
v_mul_f32 v57, v57, v4
v_mul_f32 v58, v58, v4
v_mul_f32 v59, v59, v4
s_waitcnt lgkmcnt(6)
v_mfma_f32_32x32x16_bf16 v[8:23], v[128:131], v[40:43], v[8:23]
ds_read_b64_tr_b16 v[148:149], v5 offset:26624
ds_read_b64_tr_b16 v[150:151], v5 offset:27136
v_mul_f32 v60, v60, v4
v_mul_f32 v61, v61, v4
v_mul_f32 v62, v62, v4
v_mul_f32 v63, v63, v4
s_waitcnt lgkmcnt(6)
v_mfma_f32_32x32x16_bf16 v[24:39], v[132:135], v[40:43], v[24:39]
v_cvt_pk_bf16_f32 v56, v56, v57
v_cvt_pk_bf16_f32 v57, v58, v59
v_cvt_pk_bf16_f32 v58, v60, v61
v_cvt_pk_bf16_f32 v59, v62, v63
s_waitcnt lgkmcnt(4)
s_waitcnt vmcnt(0)
v_mfma_f32_32x32x16_bf16 v[40:55], v[72:75], v[216:219], 0
v_add_f32 v4, s20, v120
v_rcp_f32 v4, v4
v_mfma_f32_32x32x16_bf16 v[40:55], v[76:79], v[220:223], v[40:55]
ds_read_b64_tr_b16 v[128:129], v2 offset:28672
ds_read_b64_tr_b16 v[130:131], v2 offset:29184
v_mul_f32 v112, v112, v4
v_mul_f32 v113, v113, v4
v_mul_f32 v114, v114, v4
v_mul_f32 v115, v115, v4
s_waitcnt lgkmcnt(4)
v_mfma_f32_32x32x16_bf16 v[8:23], v[144:147], v[56:59], v[8:23]
ds_read_b64_tr_b16 v[132:133], v5 offset:28672
ds_read_b64_tr_b16 v[134:135], v5 offset:29184
v_mul_f32 v116, v116, v4
v_mul_f32 v117, v117, v4
v_mul_f32 v118, v118, v4
v_mul_f32 v119, v119, v4
s_waitcnt lgkmcnt(4)
v_mfma_f32_32x32x16_bf16 v[24:39], v[148:151], v[56:59], v[24:39]
v_cvt_pk_bf16_f32 v112, v112, v113
v_cvt_pk_bf16_f32 v113, v114, v115
v_cvt_pk_bf16_f32 v114, v116, v117
v_cvt_pk_bf16_f32 v115, v118, v119
v_add_f32 v4, s20, v48
v_rcp_f32 v4, v4
ds_read_b64_tr_b16 v[144:145], v2 offset:30720
ds_read_b64_tr_b16 v[146:147], v2 offset:31232
v_mul_f32 v40, v40, v4
v_mul_f32 v41, v41, v4
v_mul_f32 v42, v42, v4
v_mul_f32 v43, v43, v4
s_waitcnt lgkmcnt(4)
v_mfma_f32_32x32x16_bf16 v[8:23], v[128:131], v[112:115], v[8:23]
ds_read_b64_tr_b16 v[148:149], v5 offset:30720
ds_read_b64_tr_b16 v[150:151], v5 offset:31232
v_mul_f32 v44, v44, v4
v_mul_f32 v45, v45, v4
v_mul_f32 v46, v46, v4
v_mul_f32 v47, v47, v4
s_waitcnt lgkmcnt(4)
v_mfma_f32_32x32x16_bf16 v[24:39], v[132:135], v[112:115], v[24:39]
v_cvt_pk_bf16_f32 v40, v40, v41
v_cvt_pk_bf16_f32 v41, v42, v43
v_cvt_pk_bf16_f32 v42, v44, v45
v_cvt_pk_bf16_f32 v43, v46, v47
s_waitcnt lgkmcnt(2)
s_nop 0
v_mfma_f32_32x32x16_bf16 v[8:23], v[144:147], v[40:43], v[8:23]
s_waitcnt lgkmcnt(0)
v_mfma_f32_32x32x16_bf16 v[24:39], v[148:151], v[40:43], v[24:39]
s_lshl_b32 s18, s3, 12
s_add_u32 s18, s18, 0x10000
v_add_u32 v5, s18, v3
s_xor_b32 s18, s3, 2
s_lshl_b32 s18, s18, 12
s_add_u32 s18, s18, 0x10000
v_add_u32 v4, s18, v3
v_xor_b32 v7, 8, v110
s_cmp_eq_u32 s11, 0
s_nop 1
s_cbranch_scc1 K2_R0
v_swap_b32 v8, v24
v_swap_b32 v9, v25
v_swap_b32 v10, v26
v_swap_b32 v11, v27
v_swap_b32 v12, v28
v_swap_b32 v13, v29
v_swap_b32 v14, v30
v_swap_b32 v15, v31
v_swap_b32 v16, v32
v_swap_b32 v17, v33
v_swap_b32 v18, v34
v_swap_b32 v19, v35
v_swap_b32 v20, v36
v_swap_b32 v21, v37
v_swap_b32 v22, v38
v_swap_b32 v23, v39
s_nop 0
K2_R0:
ds_write_b128 v5, v[24:27] offset:0
ds_write_b128 v5, v[28:31] offset:1024
ds_write_b128 v5, v[32:35] offset:2048
ds_write_b128 v5, v[36:39] offset:3072
ds_write_b32 v110, v111 offset:224
v_and_b32 v5, 31, v0
v_lshrrev_b32 v2, 5, v0
v_lshlrev_b32 v2, 4, v2
v_lshl_or_b32 v5, v5, 11, v2
s_lshl_b32 s18, s8, 6
s_lshl_b32 s19, s10, 5
s_add_u32 s18, s18, s19
s_lshl_b32 s18, s18, 11
s_lshl_b32 s19, s9, 7
s_add_u32 s18, s18, s19
s_lshl_b32 s19, s11, 6
s_add_u32 s18, s18, s19
FW19:
ds_read_b32 v6, v7 offset:224
s_waitcnt lgkmcnt(0)
v_cmp_eq_u32 vcc, 0, v6
s_nop 3
s_cbranch_vccz FW19_D
s_branch FW19
FW19_D:
ds_read_b128 v[40:43], v4 offset:0
ds_read_b128 v[44:47], v4 offset:1024
ds_read_b128 v[48:51], v4 offset:2048
ds_read_b128 v[52:55], v4 offset:3072
s_waitcnt lgkmcnt(3)
v_add_f32 v8, v8, v40
v_add_f32 v9, v9, v41
v_add_f32 v10, v10, v42
v_add_f32 v11, v11, v43
s_waitcnt lgkmcnt(2)
v_add_f32 v12, v12, v44
v_add_f32 v13, v13, v45
v_add_f32 v14, v14, v46
v_add_f32 v15, v15, v47
s_waitcnt lgkmcnt(1)
v_add_f32 v16, v16, v48
v_add_f32 v17, v17, v49
v_add_f32 v18, v18, v50
v_add_f32 v19, v19, v51
s_waitcnt lgkmcnt(0)
v_add_f32 v20, v20, v52
v_add_f32 v21, v21, v53
v_add_f32 v22, v22, v54
v_add_f32 v23, v23, v55
v_cvt_pk_bf16_f32 v56, v8, v9
v_cvt_pk_bf16_f32 v57, v10, v11
v_cvt_pk_bf16_f32 v58, v12, v13
v_cvt_pk_bf16_f32 v59, v14, v15
v_cvt_pk_bf16_f32 v60, v16, v17
v_cvt_pk_bf16_f32 v61, v18, v19
v_cvt_pk_bf16_f32 v62, v20, v21
v_cvt_pk_bf16_f32 v63, v22, v23
buffer_store_dwordx4 v[56:59], v5, s[96:99], s18 offen nt
buffer_store_dwordx4 v[60:63], v5, s[96:99], s18 offen offset:32 nt
s_endpgm
KVS1:
FW20:
ds_read_b32 v6, v109 offset:160
s_waitcnt lgkmcnt(0)
v_cmp_eq_u32 vcc, 0, v6
s_nop 3
s_cbranch_vccz FW20_D
s_branch FW20
FW20_D:
s_branch KVB1
KVS2:
FW21:
ds_read_b32 v6, v109 offset:176
s_waitcnt lgkmcnt(0)
v_cmp_eq_u32 vcc, 0, v6
s_nop 3
s_cbranch_vccz FW21_D
s_branch FW21
FW21_D:
s_branch KVB2
KVS3:
FW22:
ds_read_b32 v6, v109 offset:192
s_waitcnt lgkmcnt(0)
v_cmp_eq_u32 vcc, 0, v6
s_nop 3
s_cbranch_vccz FW22_D
s_branch FW22
FW22_D:
s_branch KVB3
K1_END:
s_endpgm
K_TEXT_END:
.set K2_NL, 5
.section .rodata,"a"
.p2align 6
.amdhsa_kernel k1_kernel
  .amdhsa_next_free_vgpr 256
  .amdhsa_next_free_sgpr 102
  .amdhsa_accum_offset 256
  .amdhsa_group_segment_fixed_size 0
  .amdhsa_kernarg_size 96
  .amdhsa_user_sgpr_count 2
  .amdhsa_user_sgpr_kernarg_segment_ptr 1
  .amdhsa_system_sgpr_workgroup_id_x 1
.end_amdhsa_kernel
```
